```python
import torch

def _softmax(x, axis=-1):
    return torch.softmax(x, dim=axis)
def _gelu(x):
    return torch.nn.functional.gelu(x, approximate="tanh")
def _silu(x):
    return torch.nn.functional.silu(x)
def _sigmoid(x):
    return torch.sigmoid(x)
def _layernorm(x, axis=-1, eps=1e-5):
    m = x.mean(dim=axis, keepdim=True)
    v = x.var(dim=axis, keepdim=True, unbiased=False)
    return (x - m) / torch.sqrt(v + eps)
def _scatter_add(tgt, idx, src, axis=0):
    return tgt.clone().index_add_(axis, idx, src)
def _segment_sum(src, seg, n):
    out = torch.zeros((n,) + src.shape[1:], dtype=src.dtype)
    return out.index_add_(0, seg, src)
def _pad(x, pw):
    flat = tuple(v for pair in reversed(pw) for v in pair)
    return torch.nn.functional.pad(x, flat)

kernel_name = 'sequential_preLN__gqa_block_cached__geglu_ffn__decode'

def setup_inputs():

    _w = (lambda a: (lambda t: t.to(torch.bfloat16) if t.is_floating_point() else t)(torch.as_tensor(a)))
    def _A_setup():
        B, Sq, D = 1, 1, 448
        Hq, Hkv, Sk, Dh = 16, 8, 32768, 256
        assert Hq % Hkv == 0, (Hq, Hkv)
        return {
            "x": _w((lambda *s: torch.randn(*s, dtype=torch.bfloat16) * 0.05)(B, Sq, D)),
            "k_cache": _w((lambda *s: torch.randn(*s, dtype=torch.bfloat16) * 3.2)(B, Hkv, Sk, Dh)),
            "v_cache": _w((lambda *s: torch.randn(*s, dtype=torch.bfloat16) * 0.4)(B, Hkv, Sk, Dh)),
            "wq": _w((lambda *s: torch.randn(*s, dtype=torch.bfloat16) * 3.2)(D, Hq * Dh) * (D ** -0.5)),
            "wo": _w((lambda *s: torch.randn(*s, dtype=torch.bfloat16) * 0.4)(Hq * Dh, D) * ((Hq * Dh) ** -0.5)),
        }
    _A_in = _A_setup()

    def _B_setup():
        B, S, D, F = 1, 1, 448, 1792
        return {
            "x": _w((lambda *s: torch.randn(*s, dtype=torch.bfloat16) * 0.05)(B, S, D)),
            "w_gate": _w((lambda *s: torch.randn(*s, dtype=torch.bfloat16) * 0.05)(D, F)),
            "w_up": _w((lambda *s: torch.randn(*s, dtype=torch.bfloat16) * 0.05)(D, F)),
            "w_down": _w((lambda *s: torch.randn(*s, dtype=torch.bfloat16) * 0.05)(F, D)),
        }
    _B_in = _B_setup()

    return {
        "A_x": _A_in["x"],
        "A_k_cache": _A_in["k_cache"],
        "A_v_cache": _A_in["v_cache"],
        "A_wq": _A_in["wq"],
        "A_wo": _A_in["wo"],
        "B_x": _B_in["x"],
        "B_w_gate": _B_in["w_gate"],
        "B_w_up": _B_in["w_up"],
        "B_w_down": _B_in["w_down"],
    }

def reference(A_x, A_k_cache, A_v_cache, A_wq, A_wo, B_x, B_w_gate, B_w_up, B_w_down):
    def _A_ref(x, k_cache, v_cache, wq, wo):
        B, Sq, D = x.shape
        Hq, Dh = 16, 256
        Hkv = k_cache.shape[1]
        rep = Hq // Hkv
        q = (lambda x, *d: x.permute(*d))((x @ wq).reshape(B, Sq, Hq, Dh), 0, 2, 1, 3)
        k = (lambda x, n, axis: torch.repeat_interleave(x, n, dim=axis))(k_cache, rep, axis=1)
        v = (lambda x, n, axis: torch.repeat_interleave(x, n, dim=axis))(v_cache, rep, axis=1)
        scores = torch.einsum("bhqd,bhkd->bhqk", q, k) * (Dh ** -0.5)
        p = _softmax(scores, axis=-1)
        o = torch.einsum("bhqk,bhkd->bhqd", p, v)
        return (lambda x, *d: x.permute(*d))(o, 0, 2, 1, 3).reshape(B, Sq, Hq * Dh) @ wo

    def _B_ref(x, w_gate, w_up, w_down):
        return (_gelu(x @ w_gate) * (x @ w_up)) @ w_down

    x = A_x
    h = x + _A_ref(_layernorm(x, axis=-1), A_k_cache, A_v_cache, A_wq, A_wo)
    h2 = h + _B_ref(_layernorm(h, axis=-1), B_w_gate, B_w_up, B_w_down)
    return h2
```

```asm
; @launch grid=(256,1,1) block=(768,1,1) lds=154880
.amdgcn_target "amdgcn-amd-amdhsa--gfx950"
.text
.globl sequential_preLN__gqa_block_cached__geglu_ffn__decode_kernel
.p2align 8
.type sequential_preLN__gqa_block_cached__geglu_ffn__decode_kernel,@function
sequential_preLN__gqa_block_cached__geglu_ffn__decode_kernel:
  s_cmp_ge_u32 s2, 256
  s_cbranch_scc1 L_end
  s_load_dwordx4 s[4:7], s[0:1], 8
  s_load_dwordx2 s[20:21], s[0:1], 88
  v_lshrrev_b32 v1, 6, v0
  s_lshr_b32 s22, s2, 5
  v_readfirstlane_b32 s3, v1
  s_and_b32 s23, s2, 31
  v_and_b32 v1, 63, v0
  s_cmp_eq_u32 s3, 8
  s_cbranch_scc1 L_helper
  s_cmp_gt_u32 s3, 8
  s_cbranch_scc1 L_support
  v_lshrrev_b32 v2, 3, v1
  v_lshlrev_b32 v2, 9, v2
  v_and_b32 v7, 7, v1
  v_lshl_add_u32 v2, v7, 4, v2
  v_add_u32 v5, 0x1000, v2
  v_and_b32 v3, 31, v1
  v_lshlrev_b32 v3, 4, v3
  v_lshrrev_b32 v6, 5, v1
  v_lshl_add_u32 v3, v6, 10, v3
  v_add_u32 v4, 0x1000, v3
  s_lshl_b32 s24, s23, 3
  s_add_u32 s24, s24, s3
  s_lshl_b32 s40, s24, 13
  s_lshl_b32 s25, s22, 24
  s_waitcnt lgkmcnt(0)
  s_add_u32 s8, s4, s25
  s_addc_u32 s9, s5, 0
  s_mov_b32 s10, 0x1000000
  s_mov_b32 s11, 0x20000
  s_add_u32 s12, s6, s25
  s_addc_u32 s13, s7, 0
  s_mov_b32 s14, 0x1000000
  s_mov_b32 s15, 0x20000
  s_barrier
  buffer_load_dwordx4 v[40:43], v2, s[8:11], s40 offen offset:0 nt
  buffer_load_dwordx4 v[44:47], v5, s[8:11], s40 offen offset:0 nt
  buffer_load_dwordx4 v[48:51], v2, s[8:11], s40 offen offset:128 nt
  s_lshl_b32 s46, s22, 8
  s_add_u32 s46, s46, 229376
  s_add_u32 s46, s20, s46
  s_addc_u32 s47, s21, 0
  s_mov_b32 s43, 1
  s_mov_b32 s59, 0
  s_mov_b32 s38, s23
  s_mov_b32 s39, 0
  s_mov_b32 s50, 0xffff0000
  s_mov_b32 s51, 0
  s_mov_b32 s52, 0
  s_mov_b32 s53, 0x0000ffff
  s_mov_b32 s54, 0
  s_mov_b32 s55, 0xffff0000
  s_mov_b32 s57, 0x05040100
  s_mov_b32 s58, 0x07060302
  s_mov_b32 s56, 0x3db8aa3b
  s_mov_b32 s16, s20
  s_mov_b32 s17, s21
  s_mov_b32 s18, 2097152
  s_mov_b32 s19, 0x20000
  s_lshl_b32 s26, s3, 12
  s_add_u32 s26, s26, 122112
  v_bfe_u32 v158, v1, 3, 1
  v_lshlrev_b32 v158, 5, v158
  v_bfe_u32 v144, v1, 1, 1
  v_lshl_add_u32 v158, v144, 4, v158
  v_bfe_u32 v144, v1, 2, 1
  v_lshl_add_u32 v158, v144, 3, v158
  v_and_b32 v144, 1, v1
  v_lshl_add_u32 v158, v144, 1, v158
  v_add_u32 v158, s26, v158
  v_lshlrev_b32 v159, 4, v6
  v_add_u32 v159, s26, v159
  v_lshrrev_b32 v144, 4, v1
  v_and_b32 v6, 7, v1
  v_xor_b32 v6, v6, v144
  v_lshlrev_b32 v6, 4, v6
  v_lshrrev_b32 v145, 3, v1
  v_lshl_add_u32 v6, v145, 7, v6
  v_add_u32 v6, s26, v6
  v_xor_b32 v7, 64, v6
  v_add_u32 v7, 0x400, v7
  v_bfe_u32 v156, v1, 1, 3
  v_xor_b32 v156, v156, v144
  v_lshlrev_b32 v156, 4, v156
  v_and_b32 v145, 15, v1
  v_lshl_add_u32 v156, v145, 7, v156
  v_add_u32 v156, s26, v156
  v_xor_b32 v157, 64, v156
  v_and_b32 v145, 1, v1
  v_lshlrev_b32 v145, 9, v145
  v_lshl_add_u32 v145, v144, 4, v145
  v_add_u32 v145, 118784, v145
  v_mov_b32 v140, 0xff800000
  v_mov_b32 v141, 0xff800000
  v_mov_b32 v142, 0
  v_mov_b32 v143, 0
  v_mov_b32 v104, 0
  v_mov_b32 v105, 0
  v_mov_b32 v106, 0
  v_mov_b32 v107, 0
  v_mov_b32 v108, 0
  v_mov_b32 v109, 0
  v_mov_b32 v110, 0
  v_mov_b32 v111, 0
  v_mov_b32 v112, 0
  v_mov_b32 v113, 0
  v_mov_b32 v114, 0
  v_mov_b32 v115, 0
  v_mov_b32 v116, 0
  v_mov_b32 v117, 0
  v_mov_b32 v118, 0
  v_mov_b32 v119, 0
  v_mov_b32 v160, 122048
  s_mov_b32 s42, 0
  s_cmp_eq_u32 s42, 4
  s_cbranch_scc1 L_fl3
  ds_read_b32 v161, v160
  s_waitcnt lgkmcnt(0)
  v_readfirstlane_b32 s42, v161
  s_cmp_eq_u32 s42, 4
  s_cbranch_scc1 L_fl3
  s_waitcnt vmcnt(2)
L_fl3:
  buffer_load_dwordx4 v[52:55], v5, s[8:11], s40 offen offset:128 nt
  s_cmp_eq_u32 s42, 4
  s_cbranch_scc1 L_fl4
  ds_read_b32 v161, v160
  s_waitcnt lgkmcnt(0)
  v_readfirstlane_b32 s42, v161
  s_cmp_eq_u32 s42, 4
  s_cbranch_scc1 L_fl4
  s_waitcnt vmcnt(2)
L_fl4:
  buffer_load_dwordx4 v[56:59], v2, s[8:11], s40 offen offset:256 nt
  s_cmp_eq_u32 s42, 4
  s_cbranch_scc1 L_fl5
  ds_read_b32 v161, v160
  s_waitcnt lgkmcnt(0)
  v_readfirstlane_b32 s42, v161
  s_cmp_eq_u32 s42, 4
  s_cbranch_scc1 L_fl5
  s_waitcnt vmcnt(2)
L_fl5:
  buffer_load_dwordx4 v[60:63], v5, s[8:11], s40 offen offset:256 nt
  s_cmp_eq_u32 s42, 4
  s_cbranch_scc1 L_fl6
  ds_read_b32 v161, v160
  s_waitcnt lgkmcnt(0)
  v_readfirstlane_b32 s42, v161
  s_cmp_eq_u32 s42, 4
  s_cbranch_scc1 L_fl6
  s_waitcnt vmcnt(2)
L_fl6:
  buffer_load_dwordx4 v[64:67], v2, s[8:11], s40 offen offset:384 nt
  s_cmp_eq_u32 s42, 4
  s_cbranch_scc1 L_fl7
  ds_read_b32 v161, v160
  s_waitcnt lgkmcnt(0)
  v_readfirstlane_b32 s42, v161
  s_cmp_eq_u32 s42, 4
  s_cbranch_scc1 L_fl7
  s_waitcnt vmcnt(2)
L_fl7:
  buffer_load_dwordx4 v[68:71], v5, s[8:11], s40 offen offset:384 nt
  s_cmp_eq_u32 s42, 4
  s_cbranch_scc1 L_fl8
  ds_read_b32 v161, v160
  s_waitcnt lgkmcnt(0)
  v_readfirstlane_b32 s42, v161
  s_cmp_eq_u32 s42, 4
  s_cbranch_scc1 L_fl8
  s_waitcnt vmcnt(2)
L_fl8:
  buffer_load_dwordx4 v[72:75], v3, s[12:15], s40 offen offset:0 nt
  s_cmp_eq_u32 s42, 4
  s_cbranch_scc1 L_fl9
  ds_read_b32 v161, v160
  s_waitcnt lgkmcnt(0)
  v_readfirstlane_b32 s42, v161
  s_cmp_eq_u32 s42, 4
  s_cbranch_scc1 L_fl9
  s_waitcnt vmcnt(2)
L_fl9:
  buffer_load_dwordx4 v[76:79], v3, s[12:15], s40 offen offset:512 nt
  s_cmp_eq_u32 s42, 4
  s_cbranch_scc1 L_fl10
  ds_read_b32 v161, v160
  s_waitcnt lgkmcnt(0)
  v_readfirstlane_b32 s42, v161
  s_cmp_eq_u32 s42, 4
  s_cbranch_scc1 L_fl10
  s_waitcnt vmcnt(2)
L_fl10:
  buffer_load_dwordx4 v[80:83], v3, s[12:15], s40 offen offset:2048 nt
  s_cmp_eq_u32 s42, 4
  s_cbranch_scc1 L_fl11
  ds_read_b32 v161, v160
  s_waitcnt lgkmcnt(0)
  v_readfirstlane_b32 s42, v161
  s_cmp_eq_u32 s42, 4
  s_cbranch_scc1 L_fl11
  s_waitcnt vmcnt(2)
L_fl11:
  buffer_load_dwordx4 v[84:87], v3, s[12:15], s40 offen offset:2560 nt
  s_cmp_eq_u32 s42, 4
  s_cbranch_scc1 L_fl12
  ds_read_b32 v161, v160
  s_waitcnt lgkmcnt(0)
  v_readfirstlane_b32 s42, v161
  s_cmp_eq_u32 s42, 4
  s_cbranch_scc1 L_fl12
  s_waitcnt vmcnt(2)
L_fl12:
  buffer_load_dwordx4 v[88:91], v4, s[12:15], s40 offen offset:0 nt
  s_cmp_eq_u32 s42, 4
  s_cbranch_scc1 L_fl13
  ds_read_b32 v161, v160
  s_waitcnt lgkmcnt(0)
  v_readfirstlane_b32 s42, v161
  s_cmp_eq_u32 s42, 4
  s_cbranch_scc1 L_fl13
  s_waitcnt vmcnt(2)
L_fl13:
  buffer_load_dwordx4 v[92:95], v4, s[12:15], s40 offen offset:512 nt
  s_cmp_eq_u32 s42, 4
  s_cbranch_scc1 L_fl14
  ds_read_b32 v161, v160
  s_waitcnt lgkmcnt(0)
  v_readfirstlane_b32 s42, v161
  s_cmp_eq_u32 s42, 4
  s_cbranch_scc1 L_fl14
  s_waitcnt vmcnt(2)
L_fl14:
  buffer_load_dwordx4 v[96:99], v4, s[12:15], s40 offen offset:2048 nt
  s_cmp_eq_u32 s42, 4
  s_cbranch_scc1 L_fl15
  ds_read_b32 v161, v160
  s_waitcnt lgkmcnt(0)
  v_readfirstlane_b32 s42, v161
  s_cmp_eq_u32 s42, 4
  s_cbranch_scc1 L_fl15
  s_waitcnt vmcnt(2)
L_fl15:
  buffer_load_dwordx4 v[100:103], v4, s[12:15], s40 offen offset:2560 nt
  s_mov_b32 s37, 320000
L_qwait:
  s_cmp_eq_u32 s42, 4
  s_cbranch_scc1 L_qready
  s_sleep 1
  ds_read_b32 v161, v160
  s_waitcnt lgkmcnt(0)
  v_readfirstlane_b32 s42, v161
  s_sub_u32 s37, s37, 1
  s_cmp_lg_u32 s37, 0
  s_cbranch_scc1 L_qwait
L_qready:
  s_barrier
  ds_read_b128 v[8:11], v145 offset:0
  ds_read_b128 v[12:15], v145 offset:64
  ds_read_b128 v[16:19], v145 offset:128
  ds_read_b128 v[20:23], v145 offset:192
  ds_read_b128 v[24:27], v145 offset:256
  ds_read_b128 v[28:31], v145 offset:320
  ds_read_b128 v[32:35], v145 offset:384
  ds_read_b128 v[36:39], v145 offset:448
  s_waitcnt lgkmcnt(0)
L_proc:
  s_cmp_lt_u32 s43, 6
  s_cbranch_scc1 L_static
  s_cmp_lt_u32 s3, 4
  s_cbranch_scc0 L_doclaim
  s_mov_b32 s41, 0x10000
  s_branch L_claimed
L_doclaim:
  s_mov_b32 s41, 1
  s_atomic_add s41, s[46:47], 0x0 glc
  s_branch L_claimed
L_static:
  s_add_u32 s39, s39, 256
  s_add_u32 s38, s38, 11
  s_and_b32 s38, s38, 31
  s_lshl_b32 s48, s38, 3
  s_add_u32 s48, s48, s3
  s_add_u32 s48, s48, s39
  s_sub_u32 s41, s48, 1536
L_claimed:
  s_add_u32 s43, s43, 1
  s_waitcnt vmcnt(14)
  ds_write_b128 v6, v[40:43] offset:0
  ds_write_b128 v7, v[44:47] offset:0
  ds_read_b128 v[120:123], v156 offset:0
  ds_read_b128 v[124:127], v157 offset:0
  s_waitcnt vmcnt(12)
  ds_write_b128 v6, v[48:51] offset:2048
  ds_write_b128 v7, v[52:55] offset:2048
  ds_read_b128 v[128:131], v156 offset:2048
  ds_read_b128 v[132:135], v157 offset:2048
  s_waitcnt lgkmcnt(4)
  v_mfma_f32_16x16x32_bf16 v[136:139], v[8:11], v[120:123], 0
  v_mfma_f32_16x16x32_bf16 v[136:139], v[12:15], v[124:127], v[136:139]
  s_waitcnt vmcnt(10)
  ds_write_b128 v6, v[56:59] offset:0
  ds_write_b128 v7, v[60:63] offset:0
  ds_read_b128 v[120:123], v156 offset:0
  ds_read_b128 v[124:127], v157 offset:0
  s_waitcnt lgkmcnt(4)
  v_mfma_f32_16x16x32_bf16 v[136:139], v[16:19], v[128:131], v[136:139]
  v_mfma_f32_16x16x32_bf16 v[136:139], v[20:23], v[132:135], v[136:139]
  s_waitcnt vmcnt(8)
  ds_write_b128 v6, v[64:67] offset:2048
  ds_write_b128 v7, v[68:71] offset:2048
  ds_read_b128 v[128:131], v156 offset:2048
  ds_read_b128 v[132:135], v157 offset:2048
  s_waitcnt lgkmcnt(4)
  v_mfma_f32_16x16x32_bf16 v[136:139], v[24:27], v[120:123], v[136:139]
  v_mfma_f32_16x16x32_bf16 v[136:139], v[28:31], v[124:127], v[136:139]
  s_waitcnt lgkmcnt(0)
  v_mfma_f32_16x16x32_bf16 v[136:139], v[32:35], v[128:131], v[136:139]
  v_mfma_f32_16x16x32_bf16 v[136:139], v[36:39], v[132:135], v[136:139]
  s_add_u32 s41, s41, 1536
  s_cmp_lt_u32 s41, 2048
  s_cselect_b32 s10, 0x1000000, 0
  s_cselect_b32 s14, 0x1000000, 0
  s_cselect_b32 s40, s41, 0
  s_mov_b32 s59, s41
  s_lshl_b32 s40, s40, 13
  buffer_load_dwordx4 v[40:43], v2, s[8:11], s40 offen offset:0 nt
  buffer_load_dwordx4 v[44:47], v5, s[8:11], s40 offen offset:0 nt
  buffer_load_dwordx4 v[48:51], v2, s[8:11], s40 offen offset:128 nt
  buffer_load_dwordx4 v[52:55], v5, s[8:11], s40 offen offset:128 nt
  buffer_load_dwordx4 v[56:59], v2, s[8:11], s40 offen offset:256 nt
  buffer_load_dwordx4 v[60:63], v5, s[8:11], s40 offen offset:256 nt
  buffer_load_dwordx4 v[64:67], v2, s[8:11], s40 offen offset:384 nt
  buffer_load_dwordx4 v[68:71], v5, s[8:11], s40 offen offset:384 nt
  v_cvt_pk_bf16_f32 v144, v136, v137
  v_lshlrev_b32 v145, 16, v144
  v_and_b32 v146, 0xffff0000, v144
  v_mov_b32 v147, v145
  v_mov_b32 v148, v146
  s_nop 0
  s_nop 0
  v_max_f32_dpp v147, v147, v147 row_ror:8 row_mask:0xf bank_mask:0xf
  v_max_f32_dpp v148, v148, v148 row_ror:8 row_mask:0xf bank_mask:0xf
  s_nop 0
  v_max_f32_dpp v147, v147, v147 row_ror:4 row_mask:0xf bank_mask:0xf
  v_max_f32_dpp v148, v148, v148 row_ror:4 row_mask:0xf bank_mask:0xf
  s_nop 0
  v_max_f32_dpp v147, v147, v147 row_ror:2 row_mask:0xf bank_mask:0xf
  v_max_f32_dpp v148, v148, v148 row_ror:2 row_mask:0xf bank_mask:0xf
  s_nop 0
  v_max_f32_dpp v147, v147, v147 row_ror:1 row_mask:0xf bank_mask:0xf
  v_max_f32_dpp v148, v148, v148 row_ror:1 row_mask:0xf bank_mask:0xf
  v_max_f32 v147, v147, v140
  v_max_f32 v148, v148, v141
  v_cmp_gt_f32 vcc, v147, v140
  v_cmp_gt_f32 s[44:45], v148, v141
  s_or_b64 vcc, vcc, s[44:45]
  s_cbranch_vccz L_norescale
  v_sub_f32 v149, v140, v147
  v_sub_f32 v150, v141, v148
  v_mul_f32 v149, s56, v149
  v_mul_f32 v150, s56, v150
  v_exp_f32 v149, v149
  v_exp_f32 v150, v150
  v_mov_b32 v140, v147
  v_mov_b32 v141, v148
  v_mul_f32 v104, v149, v104
  v_mul_f32 v112, v150, v112
  v_mul_f32 v105, v149, v105
  v_mul_f32 v113, v150, v113
  v_mul_f32 v106, v149, v106
  v_mul_f32 v114, v150, v114
  v_mul_f32 v107, v149, v107
  v_mul_f32 v115, v150, v115
  v_mul_f32 v108, v149, v108
  v_mul_f32 v116, v150, v116
  v_mul_f32 v109, v149, v109
  v_mul_f32 v117, v150, v117
  v_mul_f32 v110, v149, v110
  v_mul_f32 v118, v150, v118
  v_mul_f32 v111, v149, v111
  v_mul_f32 v119, v150, v119
  v_mul_f32 v142, v149, v142
  v_mul_f32 v143, v150, v143
L_norescale:
  v_mul_f32 v149, s56, v140
  v_mul_f32 v150, s56, v141
  v_fma_f32 v145, v145, s56, -v149
  v_fma_f32 v146, v146, s56, -v150
  v_exp_f32 v145, v145
  v_exp_f32 v146, v146
  s_nop 0
  v_cvt_pk_bf16_f32 v144, v145, v146
  v_add_f32 v142, v142, v145
  v_add_f32 v143, v143, v146
  s_mov_b64 exec, 0xffff
  ds_write_b16 v158, v144
  ds_write_b16_d16_hi v158, v144 offset:4
  s_mov_b64 exec, -1
  ds_read_b128 v[128:131], v159
  ds_read_b128 v[132:135], v159 offset:32
L_aftersm:
  s_waitcnt vmcnt(14)
  v_perm_b32 v120, v76, v72, s57
  v_perm_b32 v121, v76, v72, s58
  v_perm_b32 v122, v77, v73, s57
  v_perm_b32 v123, v77, v73, s58
  v_perm_b32 v124, v78, v74, s57
  v_perm_b32 v125, v78, v74, s58
  v_perm_b32 v126, v79, v75, s57
  v_perm_b32 v127, v79, v75, s58
  s_waitcnt lgkmcnt(1)
  v_dot2c_f32_bf16 v104, v120, v128
  v_dot2c_f32_bf16 v105, v121, v128
  v_dot2c_f32_bf16 v106, v122, v128
  v_dot2c_f32_bf16 v107, v123, v128
  v_dot2c_f32_bf16 v108, v124, v128
  v_dot2c_f32_bf16 v109, v125, v128
  v_dot2c_f32_bf16 v110, v126, v128
  v_dot2c_f32_bf16 v111, v127, v128
  v_dot2c_f32_bf16 v112, v120, v129
  v_dot2c_f32_bf16 v113, v121, v129
  v_dot2c_f32_bf16 v114, v122, v129
  v_dot2c_f32_bf16 v115, v123, v129
  v_dot2c_f32_bf16 v116, v124, v129
  v_dot2c_f32_bf16 v117, v125, v129
  v_dot2c_f32_bf16 v118, v126, v129
  v_dot2c_f32_bf16 v119, v127, v129
  s_waitcnt vmcnt(12)
  v_perm_b32 v120, v84, v80, s57
  v_perm_b32 v121, v84, v80, s58
  v_perm_b32 v122, v85, v81, s57
  v_perm_b32 v123, v85, v81, s58
  v_perm_b32 v124, v86, v82, s57
  v_perm_b32 v125, v86, v82, s58
  v_perm_b32 v126, v87, v83, s57
  v_perm_b32 v127, v87, v83, s58
  v_dot2c_f32_bf16 v104, v120, v130
  v_dot2c_f32_bf16 v105, v121, v130
  v_dot2c_f32_bf16 v106, v122, v130
  v_dot2c_f32_bf16 v107, v123, v130
  v_dot2c_f32_bf16 v108, v124, v130
  v_dot2c_f32_bf16 v109, v125, v130
  v_dot2c_f32_bf16 v110, v126, v130
  v_dot2c_f32_bf16 v111, v127, v130
  v_dot2c_f32_bf16 v112, v120, v131
  v_dot2c_f32_bf16 v113, v121, v131
  v_dot2c_f32_bf16 v114, v122, v131
  v_dot2c_f32_bf16 v115, v123, v131
  v_dot2c_f32_bf16 v116, v124, v131
  v_dot2c_f32_bf16 v117, v125, v131
  v_dot2c_f32_bf16 v118, v126, v131
  v_dot2c_f32_bf16 v119, v127, v131
  s_waitcnt vmcnt(10)
  v_perm_b32 v120, v92, v88, s57
  v_perm_b32 v121, v92, v88, s58
  v_perm_b32 v122, v93, v89, s57
  v_perm_b32 v123, v93, v89, s58
  v_perm_b32 v124, v94, v90, s57
  v_perm_b32 v125, v94, v90, s58
  v_perm_b32 v126, v95, v91, s57
  v_perm_b32 v127, v95, v91, s58
  s_waitcnt lgkmcnt(0)
  v_dot2c_f32_bf16 v104, v120, v132
  v_dot2c_f32_bf16 v105, v121, v132
  v_dot2c_f32_bf16 v106, v122, v132
  v_dot2c_f32_bf16 v107, v123, v132
  v_dot2c_f32_bf16 v108, v124, v132
  v_dot2c_f32_bf16 v109, v125, v132
  v_dot2c_f32_bf16 v110, v126, v132
  v_dot2c_f32_bf16 v111, v127, v132
  v_dot2c_f32_bf16 v112, v120, v133
  v_dot2c_f32_bf16 v113, v121, v133
  v_dot2c_f32_bf16 v114, v122, v133
  v_dot2c_f32_bf16 v115, v123, v133
  v_dot2c_f32_bf16 v116, v124, v133
  v_dot2c_f32_bf16 v117, v125, v133
  v_dot2c_f32_bf16 v118, v126, v133
  v_dot2c_f32_bf16 v119, v127, v133
  s_waitcnt vmcnt(8)
  v_perm_b32 v120, v100, v96, s57
  v_perm_b32 v121, v100, v96, s58
  v_perm_b32 v122, v101, v97, s57
  v_perm_b32 v123, v101, v97, s58
  v_perm_b32 v124, v102, v98, s57
  v_perm_b32 v125, v102, v98, s58
  v_perm_b32 v126, v103, v99, s57
  v_perm_b32 v127, v103, v99, s58
  v_dot2c_f32_bf16 v104, v120, v134
  v_dot2c_f32_bf16 v105, v121, v134
  v_dot2c_f32_bf16 v106, v122, v134
  v_dot2c_f32_bf16 v107, v123, v134
  v_dot2c_f32_bf16 v108, v124, v134
  v_dot2c_f32_bf16 v109, v125, v134
  v_dot2c_f32_bf16 v110, v126, v134
  v_dot2c_f32_bf16 v111, v127, v134
  v_dot2c_f32_bf16 v112, v120, v135
  v_dot2c_f32_bf16 v113, v121, v135
  v_dot2c_f32_bf16 v114, v122, v135
  v_dot2c_f32_bf16 v115, v123, v135
  v_dot2c_f32_bf16 v116, v124, v135
  v_dot2c_f32_bf16 v117, v125, v135
  v_dot2c_f32_bf16 v118, v126, v135
  v_dot2c_f32_bf16 v119, v127, v135
  buffer_load_dwordx4 v[72:75], v3, s[12:15], s40 offen offset:0 nt
  buffer_load_dwordx4 v[76:79], v3, s[12:15], s40 offen offset:512 nt
  buffer_load_dwordx4 v[80:83], v3, s[12:15], s40 offen offset:2048 nt
  buffer_load_dwordx4 v[84:87], v3, s[12:15], s40 offen offset:2560 nt
  buffer_load_dwordx4 v[88:91], v4, s[12:15], s40 offen offset:0 nt
  buffer_load_dwordx4 v[92:95], v4, s[12:15], s40 offen offset:512 nt
  buffer_load_dwordx4 v[96:99], v4, s[12:15], s40 offen offset:2048 nt
  buffer_load_dwordx4 v[100:103], v4, s[12:15], s40 offen offset:2560 nt
  s_cmp_lg_u32 s10, 0
  s_cbranch_scc1 L_proc
L_stream_done:
  s_waitcnt vmcnt(0)
  s_cmp_lg_u32 s3, 0
  s_cbranch_scc1 L_nopf
  s_getpc_b64 s[44:45]
L_pc2:
  v_lshlrev_b32 v144, 7, v1
  v_cmp_gt_u32 vcc, L_helper - L_pc2, v144
  s_and_saveexec_b64 s[46:47], vcc
  global_load_dword v145, v144, s[44:45]
  s_mov_b64 exec, s[46:47]
L_nopf:
  s_nop 1
  s_nop 0
  v_add_f32_dpp v142, v142, v142 row_ror:8 row_mask:0xf bank_mask:0xf
  v_add_f32_dpp v143, v143, v143 row_ror:8 row_mask:0xf bank_mask:0xf
  s_nop 0
  v_add_f32_dpp v142, v142, v142 row_ror:4 row_mask:0xf bank_mask:0xf
  v_add_f32_dpp v143, v143, v143 row_ror:4 row_mask:0xf bank_mask:0xf
  s_nop 0
  v_add_f32_dpp v142, v142, v142 row_ror:2 row_mask:0xf bank_mask:0xf
  v_add_f32_dpp v143, v143, v143 row_ror:2 row_mask:0xf bank_mask:0xf
  s_nop 0
  v_add_f32_dpp v142, v142, v142 row_ror:1 row_mask:0xf bank_mask:0xf
  v_add_f32_dpp v143, v143, v143 row_ror:1 row_mask:0xf bank_mask:0xf
  s_lshl_b32 s27, s3, 2
  s_add_u32 s27, s27, 121856
  v_mov_b32 v144, s27
  s_mov_b64 exec, 1
  ds_write2_b32 v144, v140, v141 offset0:0 offset1:8
  ds_write2_b32 v144, v142, v143 offset0:16 offset1:24
  s_mov_b64 exec, -1
  s_nop 2
  v_permlane32_swap_b32 v104, v112
  v_permlane32_swap_b32 v105, v113
  v_permlane32_swap_b32 v106, v114
  v_permlane32_swap_b32 v107, v115
  v_permlane32_swap_b32 v108, v116
  v_permlane32_swap_b32 v109, v117
  v_permlane32_swap_b32 v110, v118
  v_permlane32_swap_b32 v111, v119
  s_nop 0
  v_add_f32 v104, v104, v112
  v_add_f32 v105, v105, v113
  v_add_f32 v106, v106, v114
  v_add_f32 v107, v107, v115
  v_add_f32 v108, v108, v116
  v_add_f32 v109, v109, v117
  v_add_f32 v110, v110, v118
  v_add_f32 v111, v111, v119
  s_lshl_b32 s27, s3, 12
  s_add_u32 s27, s27, 123136
  v_lshlrev_b32 v24, 5, v1
  v_add_u32 v24, s27, v24
  ds_write_b128 v24, v[104:107]
  ds_write_b128 v24, v[108:111] offset:16
  s_waitcnt lgkmcnt(0)
  s_barrier
  s_cmp_gt_u32 s3, 1
  s_cbranch_scc1 L_roles
  s_lshl_b32 s27, s3, 5
  s_add_u32 s27, s27, 121856
  v_mov_b32 v25, s27
  ds_read_b128 v[8:11], v25
  ds_read_b128 v[12:15], v25 offset:16
  ds_read_b128 v[16:19], v25 offset:64
  ds_read_b128 v[20:23], v25 offset:80
  v_lshlrev_b32 v24, 4, v0
  v_add_u32 v25, 123136, v24
  ds_read_b128 v[28:31], v25 offset:0
  ds_read_b128 v[32:35], v25 offset:4096
  ds_read_b128 v[36:39], v25 offset:8192
  ds_read_b128 v[40:43], v25 offset:12288
  ds_read_b128 v[44:47], v25 offset:16384
  ds_read_b128 v[48:51], v25 offset:20480
  ds_read_b128 v[52:55], v25 offset:24576
  ds_read_b128 v[56:59], v25 offset:28672
  s_lshl_b32 s27, s2, 11
  s_add_u32 s27, s27, 262144
  v_add_u32 v24, s27, v24
  s_waitcnt lgkmcnt(10)
  v_max3_f32 v60, v8, v9, v10
  v_max3_f32 v60, v60, v11, v12
  v_max3_f32 v60, v60, v13, v14
  v_max_f32 v60, v60, v15
  v_mul_f32 v61, s56, v60
  v_fma_f32 v8, v8, s56, -v61
  v_fma_f32 v9, v9, s56, -v61
  v_fma_f32 v10, v10, s56, -v61
  v_fma_f32 v11, v11, s56, -v61
  v_fma_f32 v12, v12, s56, -v61
  v_fma_f32 v13, v13, s56, -v61
  v_fma_f32 v14, v14, s56, -v61
  v_fma_f32 v15, v15, s56, -v61
  v_exp_f32 v8, v8
  v_exp_f32 v9, v9
  v_exp_f32 v10, v10
  v_exp_f32 v11, v11
  v_exp_f32 v12, v12
  v_exp_f32 v13, v13
  v_exp_f32 v14, v14
  v_exp_f32 v15, v15
  s_waitcnt lgkmcnt(7)
  v_mul_f32 v28, v8, v28
  v_mul_f32 v29, v8, v29
  v_mul_f32 v30, v8, v30
  v_mul_f32 v31, v8, v31
  s_waitcnt lgkmcnt(6)
  v_fma_f32 v28, v9, v32, v28
  v_fma_f32 v29, v9, v33, v29
  v_fma_f32 v30, v9, v34, v30
  v_fma_f32 v31, v9, v35, v31
  s_waitcnt lgkmcnt(5)
  v_fma_f32 v28, v10, v36, v28
  v_fma_f32 v29, v10, v37, v29
  v_fma_f32 v30, v10, v38, v30
  v_fma_f32 v31, v10, v39, v31
  s_waitcnt lgkmcnt(4)
  v_fma_f32 v28, v11, v40, v28
  v_fma_f32 v29, v11, v41, v29
  v_fma_f32 v30, v11, v42, v30
  v_fma_f32 v31, v11, v43, v31
  s_waitcnt lgkmcnt(3)
  v_fma_f32 v28, v12, v44, v28
  v_fma_f32 v29, v12, v45, v29
  v_fma_f32 v30, v12, v46, v30
  v_fma_f32 v31, v12, v47, v31
  s_waitcnt lgkmcnt(2)
  v_fma_f32 v28, v13, v48, v28
  v_fma_f32 v29, v13, v49, v29
  v_fma_f32 v30, v13, v50, v30
  v_fma_f32 v31, v13, v51, v31
  s_waitcnt lgkmcnt(1)
  v_fma_f32 v28, v14, v52, v28
  v_fma_f32 v29, v14, v53, v29
  v_fma_f32 v30, v14, v54, v30
  v_fma_f32 v31, v14, v55, v31
  s_waitcnt lgkmcnt(0)
  v_fma_f32 v28, v15, v56, v28
  v_fma_f32 v29, v15, v57, v29
  v_fma_f32 v30, v15, v58, v30
  v_fma_f32 v31, v15, v59, v31
  global_store_dwordx4 v24, v[28:31], s[20:21] sc1
  v_mul_f32 v61, v8, v16
  v_fma_f32 v61, v9, v17, v61
  v_fma_f32 v61, v10, v18, v61
  v_fma_f32 v61, v11, v19, v61
  v_fma_f32 v61, v12, v20, v61
  v_fma_f32 v61, v13, v21, v61
  v_fma_f32 v61, v14, v22, v61
  v_fma_f32 v61, v15, v23, v61
  s_lshl_b32 s27, s2, 4
  s_lshl_b32 s28, s3, 3
  s_add_u32 s27, s27, s28
  s_add_u32 s27, s27, 786432
  v_mov_b32 v24, s27
  s_mov_b64 exec, 1
  global_store_dwordx2 v24, v[60:61], s[20:21] sc1
  s_mov_b64 exec, -1
L_roles:
  s_bitcmp1_b32 s23, 0
  s_cbranch_scc1 L_exit
  s_cmp_lt_u32 s23, 8
  s_cbranch_scc1 L_t1
  s_cmp_lt_u32 s23, 22
  s_cbranch_scc1 L_ffn
  s_cmp_lg_u32 s23, 22
  s_cbranch_scc1 L_exit
  s_cmp_lt_u32 s22, 7
  s_cbranch_scc1 L_fin
  s_branch L_exit
L_t1:
  s_lshr_b32 s24, s23, 1
  v_lshrrev_b32 v2, 2, v1
  v_mul_u32_u24 v2, 928, v2
  v_and_b32 v3, 3, v1
  v_lshl_add_u32 v2, v3, 3, v2
  s_lshl_b32 s25, s3, 7
  v_add_u32 v2, s25, v2
  v_add_u32 v3, 59392, v2
  s_cmp_eq_u32 s3, 7
  s_cbranch_scc1 L_t1_nob
  ds_read_b64_tr_b16 v[64:65], v2 offset:0
  ds_read_b64_tr_b16 v[66:67], v2 offset:14848
  ds_read_b64_tr_b16 v[68:69], v2 offset:32
  ds_read_b64_tr_b16 v[70:71], v2 offset:14880
  ds_read_b64_tr_b16 v[72:73], v2 offset:64
  ds_read_b64_tr_b16 v[74:75], v2 offset:14912
  ds_read_b64_tr_b16 v[76:77], v2 offset:96
  ds_read_b64_tr_b16 v[78:79], v2 offset:14944
  s_waitcnt lgkmcnt(0)
  ds_read_b64_tr_b16 v[80:81], v2 offset:29696
  ds_read_b64_tr_b16 v[82:83], v2 offset:44544
  ds_read_b64_tr_b16 v[84:85], v2 offset:29728
  ds_read_b64_tr_b16 v[86:87], v2 offset:44576
  ds_read_b64_tr_b16 v[88:89], v2 offset:29760
  ds_read_b64_tr_b16 v[90:91], v2 offset:44608
  ds_read_b64_tr_b16 v[92:93], v2 offset:29792
  ds_read_b64_tr_b16 v[94:95], v2 offset:44640
  s_waitcnt lgkmcnt(0)
  ds_read_b64_tr_b16 v[96:97], v3 offset:0
  ds_read_b64_tr_b16 v[98:99], v3 offset:14848
  ds_read_b64_tr_b16 v[100:101], v3 offset:32
  ds_read_b64_tr_b16 v[102:103], v3 offset:14880
  ds_read_b64_tr_b16 v[104:105], v3 offset:64
  ds_read_b64_tr_b16 v[106:107], v3 offset:14912
  ds_read_b64_tr_b16 v[108:109], v3 offset:96
  ds_read_b64_tr_b16 v[110:111], v3 offset:14944
  s_waitcnt lgkmcnt(0)
  ds_read_b64_tr_b16 v[112:113], v3 offset:29696
  ds_read_b64_tr_b16 v[114:115], v3 offset:44544
  ds_read_b64_tr_b16 v[116:117], v3 offset:29728
  ds_read_b64_tr_b16 v[118:119], v3 offset:44576
  ds_read_b64_tr_b16 v[120:121], v3 offset:29760
  ds_read_b64_tr_b16 v[122:123], v3 offset:44608
  ds_read_b64_tr_b16 v[124:125], v3 offset:29792
  ds_read_b64_tr_b16 v[126:127], v3 offset:44640
  s_waitcnt lgkmcnt(0)
L_t1_nob:
  s_lshl_b32 s26, s22, 5
  v_lshrrev_b32 v6, 5, v1
  v_and_b32 v7, 31, v1
  s_lshl_b32 s27, s3, 2
  s_add_u32 s27, s27, s26
  v_add_u32 v8, s27, v6
  v_lshlrev_b32 v9, 11, v8
  v_lshl_add_u32 v9, v7, 4, v9
  s_lshl_b32 s28, s24, 9
  s_add_u32 s28, s28, 264192
  v_add_u32 v9, s28, v9
  s_lshr_b32 s29, s24, 1
  s_lshl_b32 s29, s29, 3
  s_add_u32 s29, s29, 786432
  v_add_u32 v11, s26, v7
  v_lshlrev_b32 v11, 4, v11
  v_add_u32 v11, s29, v11
  s_lshl_b32 s27, s3, 2
  v_add_u32 v10, s27, v6
  v_lshlrev_b32 v10, 2, v10
  v_add_u32 v22, 8, v10
  v_lshl_add_u32 v52, v7, 2, v6
  v_lshlrev_b32 v52, 2, v52
  s_lshl_b32 s27, s3, 9
  s_add_u32 s27, s27, 122112
  v_add_u32 v52, s27, v52
  v_lshlrev_b32 v53, 3, v1
  v_add_u32 v53, 122112, v53
  v_lshrrev_b32 v54, 4, v1
  v_lshlrev_b32 v55, 4, v54
  v_lshlrev_b32 v54, 6, v54
  v_bfe_u32 v56, v1, 1, 2
  v_lshl_add_u32 v54, v56, 4, v54
  v_bfe_u32 v56, v1, 3, 1
  v_lshl_add_u32 v54, v56, 3, v54
  v_and_b32 v56, 1, v1
  v_lshl_add_u32 v54, v56, 2, v54
  s_lshl_b32 s27, s3, 10
  s_add_u32 s27, s27, 138496
  v_add_u32 v54, s27, v54
  v_add_u32 v55, s27, v55
  s_lshl_b32 s27, s22, 2
  s_add_u32 s27, s27, s24
  s_lshl_b32 s27, s27, 11
  s_add_u32 s27, s27, 802816
  s_lshl_b32 s28, s3, 8
  s_add_u32 s27, s27, s28
  v_lshlrev_b32 v56, 2, v1
  v_add_u32 v56, s27, v56
  s_mov_b32 s31, 7
  s_mov_b32 s30, 20000
L_t1_1:
  s_bitcmp1_b32 s31, 0
  s_cbranch_scc0 L_t1_1_nl0
  global_load_dwordx4 v[12:15], v9, s[20:21] offset:-2048 sc1
L_t1_1_nl0:
  s_bitcmp1_b32 s31, 1
  s_cbranch_scc0 L_t1_1_nl1
  global_load_dwordx4 v[16:19], v9, s[20:21] offset:2048 sc1
L_t1_1_nl1:
  s_bitcmp1_b32 s31, 2
  s_cbranch_scc0 L_t1_1_nl2
  global_load_dwordx2 v[20:21], v11, s[20:21] sc1
L_t1_1_nl2:
  s_waitcnt vmcnt(0)
  v_max3_u32 v24, v12, v13, v14
  v_max_u32 v24, v24, v15
  v_cmp_eq_u32 vcc, -1, v24
  s_cbranch_vccnz L_t1_1_nc0
  s_bitset0_b32 s31, 0
L_t1_1_nc0:
  v_max3_u32 v24, v16, v17, v18
  v_max_u32 v24, v24, v19
  v_cmp_eq_u32 vcc, -1, v24
  s_cbranch_vccnz L_t1_1_nc1
  s_bitset0_b32 s31, 1
L_t1_1_nc1:
  v_max_u32 v24, v20, v21
  v_cmp_eq_u32 vcc, -1, v24
  s_cbranch_vccnz L_t1_1_nc2
  s_bitset0_b32 s31, 2
L_t1_1_nc2:
  s_cmp_eq_u32 s31, 0
  s_cbranch_scc1 L_t1_done_2
  s_sub_u32 s30, s30, 1
  s_cmp_lg_u32 s30, 0
  s_cbranch_scc1 L_t1_1
L_t1_done_2:
  v_mov_b32 v25, v20
  s_nop 1
  s_nop 1
  v_max_f32_dpp v25, v25, v25 row_ror:8 row_mask:0xf bank_mask:0xf
  s_nop 1
  v_max_f32_dpp v25, v25, v25 row_ror:4 row_mask:0xf bank_mask:0xf
  s_nop 1
  v_max_f32_dpp v25, v25, v25 row_ror:2 row_mask:0xf bank_mask:0xf
  s_nop 1
  v_max_f32_dpp v25, v25, v25 row_ror:1 row_mask:0xf bank_mask:0xf
  s_nop 0
  v_mov_b32 v26, v25
  s_nop 1
  v_permlane16_swap_b32 v25, v26
  s_nop 0
  v_max_f32 v25, v25, v26
  v_sub_f32 v27, v20, v25
  v_mul_f32 v27, s56, v27
  v_exp_f32 v27, v27
  s_nop 0
  ds_bpermute_b32 v28, v10, v27
  ds_bpermute_b32 v29, v22, v27
  v_mul_f32 v31, v27, v21
  s_nop 1
  s_nop 1
  v_add_f32_dpp v31, v31, v31 row_ror:8 row_mask:0xf bank_mask:0xf
  s_nop 1
  v_add_f32_dpp v31, v31, v31 row_ror:4 row_mask:0xf bank_mask:0xf
  s_nop 1
  v_add_f32_dpp v31, v31, v31 row_ror:2 row_mask:0xf bank_mask:0xf
  s_nop 1
  v_add_f32_dpp v31, v31, v31 row_ror:1 row_mask:0xf bank_mask:0xf
  s_waitcnt lgkmcnt(0)
  v_mul_f32 v12, v28, v12
  v_mul_f32 v13, v28, v13
  v_mul_f32 v14, v28, v14
  v_mul_f32 v15, v28, v15
  v_fma_f32 v12, v29, v16, v12
  v_fma_f32 v13, v29, v17, v13
  v_fma_f32 v14, v29, v18, v14
  v_fma_f32 v15, v29, v19, v15
  s_nop 1
  v_permlane32_swap_b32 v12, v13
  v_permlane32_swap_b32 v14, v15
  s_nop 0
  v_add_f32 v12, v12, v13
  v_add_f32 v14, v14, v15
  ds_write_b32 v52, v12
  ds_write_b32 v52, v14 offset:8
  s_nop 0
  v_mov_b32 v26, v31
  s_nop 1
  v_permlane16_swap_b32 v31, v26
  s_nop 0
  v_add_f32 v31, v31, v26
  v_rcp_f32 v30, v31
  s_waitcnt lgkmcnt(0)
  s_barrier
  s_cmp_eq_u32 s3, 7
  s_cbranch_scc1 L_exit
  ds_read_b64 v[32:33], v53 offset:0
  ds_read_b64 v[34:35], v53 offset:512
  ds_read_b64 v[36:37], v53 offset:1024
  ds_read_b64 v[38:39], v53 offset:1536
  ds_read_b64 v[40:41], v53 offset:2048
  ds_read_b64 v[42:43], v53 offset:2560
  ds_read_b64 v[44:45], v53 offset:3072
  ds_read_b64 v[46:47], v53 offset:3584
  v_fma_f32 v26, -v31, v30, 1.0
  v_fma_f32 v30, v26, v30, v30
  s_waitcnt lgkmcnt(6)
  v_add_f32 v32, v32, v34
  v_add_f32 v33, v33, v35
  s_waitcnt lgkmcnt(5)
  v_add_f32 v32, v32, v36
  v_add_f32 v33, v33, v37
  s_waitcnt lgkmcnt(4)
  v_add_f32 v32, v32, v38
  v_add_f32 v33, v33, v39
  s_waitcnt lgkmcnt(3)
  v_add_f32 v32, v32, v40
  v_add_f32 v33, v33, v41
  s_waitcnt lgkmcnt(2)
  v_add_f32 v32, v32, v42
  v_add_f32 v33, v33, v43
  s_waitcnt lgkmcnt(1)
  v_add_f32 v32, v32, v44
  v_add_f32 v33, v33, v45
  s_waitcnt lgkmcnt(0)
  v_add_f32 v32, v32, v46
  v_add_f32 v33, v33, v47
  v_mul_f32 v32, v30, v32
  v_mul_f32 v33, v30, v33
  v_cvt_pk_bf16_f32 v34, v32, v33
  ds_write_b32 v54, v34
  s_waitcnt lgkmcnt(0)
  ds_read_b128 v[36:39], v55 offset:0
  ds_read_b128 v[40:43], v55 offset:64
  ds_read_b128 v[44:47], v55 offset:128
  ds_read_b128 v[48:51], v55 offset:192
  s_waitcnt lgkmcnt(3)
  v_mfma_f32_16x16x32_bf16 v[128:131], v[36:39], v[64:67], 0
  v_mfma_f32_16x16x32_bf16 v[132:135], v[36:39], v[68:71], 0
  v_mfma_f32_16x16x32_bf16 v[136:139], v[36:39], v[72:75], 0
  v_mfma_f32_16x16x32_bf16 v[140:143], v[36:39], v[76:79], 0
  s_waitcnt lgkmcnt(2)
  v_mfma_f32_16x16x32_bf16 v[128:131], v[40:43], v[80:83], v[128:131]
  v_mfma_f32_16x16x32_bf16 v[132:135], v[40:43], v[84:87], v[132:135]
  v_mfma_f32_16x16x32_bf16 v[136:139], v[40:43], v[88:91], v[136:139]
  v_mfma_f32_16x16x32_bf16 v[140:143], v[40:43], v[92:95], v[140:143]
  s_waitcnt lgkmcnt(1)
  v_mfma_f32_16x16x32_bf16 v[128:131], v[44:47], v[96:99], v[128:131]
  v_mfma_f32_16x16x32_bf16 v[132:135], v[44:47], v[100:103], v[132:135]
  v_mfma_f32_16x16x32_bf16 v[136:139], v[44:47], v[104:107], v[136:139]
  v_mfma_f32_16x16x32_bf16 v[140:143], v[44:47], v[108:111], v[140:143]
  s_waitcnt lgkmcnt(0)
  v_mfma_f32_16x16x32_bf16 v[128:131], v[48:51], v[112:115], v[128:131]
  v_mfma_f32_16x16x32_bf16 v[132:135], v[48:51], v[116:119], v[132:135]
  v_mfma_f32_16x16x32_bf16 v[136:139], v[48:51], v[120:123], v[136:139]
  v_mfma_f32_16x16x32_bf16 v[140:143], v[48:51], v[124:127], v[140:143]
  s_nop 7
  v_cndmask_b32 v21, v128, v132, s[50:51]
  v_cndmask_b32 v21, v21, v136, s[52:53]
  v_cndmask_b32 v21, v21, v140, s[54:55]
  s_nop 1
  v_mov_b32_dpp v24, v21 quad_perm:[0,0,0,0] row_mask:0xf bank_mask:0xf
  v_mov_b32_dpp v25, v21 quad_perm:[1,1,1,1] row_mask:0xf bank_mask:0xf
  v_mov_b32_dpp v26, v21 quad_perm:[2,2,2,2] row_mask:0xf bank_mask:0xf
  v_mov_b32_dpp v27, v21 quad_perm:[3,3,3,3] row_mask:0xf bank_mask:0xf
  s_mov_b32 exec_lo, 0x11111111
  s_mov_b32 exec_hi, 0x11111111
  global_store_dwordx4 v56, v[24:27], s[20:21] sc1
  s_mov_b64 exec, -1
  s_branch L_exit
L_ffn:
  s_sub_u32 s24, s23, 8
  s_lshr_b32 s24, s24, 1
  s_lshl_b32 s24, s24, 3
  s_add_u32 s24, s24, s22
  v_lshrrev_b32 v2, 2, v1
  v_and_b32 v3, 3, v1
  v_bfe_u32 v4, v1, 4, 1
  v_lshlrev_b32 v5, 6, v2
  v_lshl_add_u32 v5, v3, 3, v5
  s_lshl_b32 s25, s3, 12
  v_add_u32 v5, s25, v5
  v_lshl_add_u32 v6, v4, 5, v5
  v_xor_b32 v4, 1, v4
  v_lshl_add_u32 v7, v4, 5, v5
  v_mul_u32_u24 v8, 928, v2
  v_lshl_add_u32 v8, v3, 3, v8
  s_lshl_b32 s25, s3, 7
  s_add_u32 s25, s25, 57344
  v_add_u32 v8, s25, v8
  s_lshl_b32 s27, s3, 10
  s_add_u32 s27, s27, 138496
  s_cmp_eq_u32 s3, 7
  s_cbranch_scc1 L_ffn_ln
  ds_read_b64_tr_b16 v[64:65], v6 offset:0
  ds_read_b64_tr_b16 v[66:67], v6 offset:1024
  ds_read_b64_tr_b16 v[68:69], v7 offset:0
  ds_read_b64_tr_b16 v[70:71], v7 offset:1024
  ds_read_b64_tr_b16 v[72:73], v6 offset:28672
  ds_read_b64_tr_b16 v[74:75], v6 offset:29696
  ds_read_b64_tr_b16 v[76:77], v7 offset:28672
  ds_read_b64_tr_b16 v[78:79], v7 offset:29696
  s_waitcnt lgkmcnt(0)
  ds_read_b64_tr_b16 v[80:81], v6 offset:2048
  ds_read_b64_tr_b16 v[82:83], v6 offset:3072
  ds_read_b64_tr_b16 v[84:85], v7 offset:2048
  ds_read_b64_tr_b16 v[86:87], v7 offset:3072
  ds_read_b64_tr_b16 v[88:89], v6 offset:30720
  ds_read_b64_tr_b16 v[90:91], v6 offset:31744
  ds_read_b64_tr_b16 v[92:93], v7 offset:30720
  ds_read_b64_tr_b16 v[94:95], v7 offset:31744
  s_waitcnt lgkmcnt(0)
  ds_read_b64_tr_b16 v[96:97], v8 offset:0
  ds_read_b64_tr_b16 v[98:99], v8 offset:14848
  ds_read_b64_tr_b16 v[100:101], v8 offset:32
  ds_read_b64_tr_b16 v[102:103], v8 offset:14880
  ds_read_b64_tr_b16 v[104:105], v8 offset:64
  ds_read_b64_tr_b16 v[106:107], v8 offset:14912
  ds_read_b64_tr_b16 v[108:109], v8 offset:96
  ds_read_b64_tr_b16 v[110:111], v8 offset:14944
  v_lshrrev_b32 v37, 4, v1
  v_lshlrev_b32 v37, 4, v37
  s_lshl_b32 s28, s3, 7
  s_add_u32 s28, s28, 145664
  v_add_u32 v37, s28, v37
  v_lshlrev_b32 v38, 2, v1
  s_lshl_b32 s28, s3, 8
  s_add_u32 s28, s28, 130304
  v_add_u32 v116, s28, v38
  v_add_u32 v117, 130304, v38
  v_bfe_u32 v118, v1, 2, 2
  v_lshlrev_b32 v118, 4, v118
  v_bfe_u32 v119, v1, 4, 1
  v_lshl_add_u32 v118, v119, 3, v118
  v_and_b32 v119, 3, v1
  v_lshl_add_u32 v118, v119, 1, v118
  v_add_u32 v118, s27, v118
  v_lshrrev_b32 v119, 4, v1
  v_lshlrev_b32 v119, 4, v119
  v_add_u32 v119, s27, v119
  s_lshl_b32 s28, s24, 11
  s_add_u32 s28, s28, 884736
  s_lshl_b32 s29, s3, 8
  s_add_u32 s28, s28, s29
  v_add_u32 v120, s28, v38
  s_mov_b32 s28, 0x3d372713
  s_mov_b32 s29, 0xc0135761
  s_branch L_ffn_bc
L_ffn_ln:
  v_lshlrev_b32 v12, 5, v1
  v_add_u32 v12, 868352, v12
  v_lshrrev_b32 v36, 2, v1
  v_lshlrev_b32 v44, 6, v36
  v_and_b32 v37, 1, v1
  v_lshl_add_u32 v44, v37, 5, v44
  v_bfe_u32 v37, v1, 1, 1
  v_lshl_add_u32 v44, v37, 3, v44
  v_add_u32 v44, 145664, v44
  s_mov_b32 exec_hi, 0x00ffffff
  s_mov_b32 s30, 20000
L_ffn_3:
  global_load_dwordx4 v[16:19], v12, s[20:21] sc1
  global_load_dwordx4 v[20:23], v12, s[20:21] offset:16 sc1
  s_waitcnt vmcnt(0)
  v_max3_u32 v14, v16, v17, v18
  v_max3_u32 v14, v14, v19, v20
  v_max3_u32 v14, v14, v21, v22
  v_max_u32 v14, v14, v23
  v_cmp_eq_u32 vcc, -1, v14
  s_cbranch_vccz L_ffn_done_4
  s_sub_u32 s30, s30, 1
  s_cmp_lg_u32 s30, 0
  s_cbranch_scc1 L_ffn_3
L_ffn_done_4:
  s_mov_b64 exec, -1
  v_readfirstlane_b32 s34, v16
  v_mov_b32 v36, 0
  v_mov_b32 v37, 0
  s_mov_b32 exec_hi, 0x00ffffff
  s_mov_b32 s35, s34
  v_pk_add_f32 v[28:29], v[16:17], s[34:35] neg_lo:[0,1] neg_hi:[0,1]
  v_pk_add_f32 v[30:31], v[18:19], s[34:35] neg_lo:[0,1] neg_hi:[0,1]
  v_pk_add_f32 v[32:33], v[20:21], s[34:35] neg_lo:[0,1] neg_hi:[0,1]
  v_pk_add_f32 v[34:35], v[22:23], s[34:35] neg_lo:[0,1] neg_hi:[0,1]
  v_pk_add_f32 v[40:41], v[28:29], v[30:31]
  v_pk_mul_f32 v[42:43], v[28:29], v[28:29]
  v_pk_add_f32 v[38:39], v[32:33], v[34:35]
  v_pk_fma_f32 v[42:43], v[30:31], v[30:31], v[42:43]
  v_pk_add_f32 v[40:41], v[40:41], v[38:39]
  v_pk_fma_f32 v[42:43], v[32:33], v[32:33], v[42:43]
  v_pk_fma_f32 v[42:43], v[34:35], v[34:35], v[42:43]
  v_add_f32 v36, v40, v41
  v_add_f32 v37, v42, v43
  s_mov_b64 exec, -1
  s_nop 1
  s_nop 0
  v_add_f32_dpp v36, v36, v36 row_ror:8 row_mask:0xf bank_mask:0xf
  v_add_f32_dpp v37, v37, v37 row_ror:8 row_mask:0xf bank_mask:0xf
  s_nop 0
  v_add_f32_dpp v36, v36, v36 row_ror:4 row_mask:0xf bank_mask:0xf
  v_add_f32_dpp v37, v37, v37 row_ror:4 row_mask:0xf bank_mask:0xf
  s_nop 0
  v_add_f32_dpp v36, v36, v36 row_ror:2 row_mask:0xf bank_mask:0xf
  v_add_f32_dpp v37, v37, v37 row_ror:2 row_mask:0xf bank_mask:0xf
  s_nop 0
  v_add_f32_dpp v36, v36, v36 row_ror:1 row_mask:0xf bank_mask:0xf
  v_add_f32_dpp v37, v37, v37 row_ror:1 row_mask:0xf bank_mask:0xf
  s_nop 0
  v_mov_b32 v38, v36
  v_mov_b32 v39, v37
  s_nop 1
  v_permlane16_swap_b32 v36, v38
  v_permlane16_swap_b32 v37, v39
  s_nop 0
  v_add_f32 v36, v36, v38
  v_add_f32 v37, v37, v39
  s_nop 0
  v_mov_b32 v38, v36
  v_mov_b32 v39, v37
  s_nop 1
  v_permlane32_swap_b32 v36, v38
  v_permlane32_swap_b32 v37, v39
  s_nop 0
  v_add_f32 v36, v36, v38
  v_add_f32 v37, v37, v39
  s_mov_b32 s35, 0x3b124925
  v_mul_f32 v36, s35, v36
  v_mul_f32 v37, s35, v37
  v_fma_f32 v37, -v36, v36, v37
  v_add_f32 v36, s34, v36
  v_max_f32 v37, 0, v37
  v_cvt_pk_bf16_f32 v38, v36, v37
  v_lshlrev_b32 v36, 16, v38
  v_and_b32 v37, 0xffff0000, v38
  v_add_f32 v37, 0x3727c5ac, v37
  v_cvt_pk_bf16_f32 v37, v37, v37
  v_and_b32 v37, 0xffff0000, v37
  v_sqrt_f32 v38, v37
  v_mov_b32 v37, v36
  v_pk_add_f32 v[28:29], v[16:17], v[36:37] neg_lo:[0,1] neg_hi:[0,1]
  v_pk_add_f32 v[30:31], v[18:19], v[36:37] neg_lo:[0,1] neg_hi:[0,1]
  v_pk_add_f32 v[32:33], v[20:21], v[36:37] neg_lo:[0,1] neg_hi:[0,1]
  v_pk_add_f32 v[34:35], v[22:23], v[36:37] neg_lo:[0,1] neg_hi:[0,1]
  v_cvt_pk_bf16_f32 v38, v38, v38
  v_and_b32 v38, 0xffff0000, v38
  v_rcp_f32 v40, v38
  v_cvt_pk_bf16_f32 v39, v28, v29
  v_lshlrev_b32 v28, 16, v39
  v_and_b32 v29, 0xffff0000, v39
  v_cvt_pk_bf16_f32 v39, v30, v31
  v_lshlrev_b32 v30, 16, v39
  v_and_b32 v31, 0xffff0000, v39
  v_cvt_pk_bf16_f32 v39, v32, v33
  v_lshlrev_b32 v32, 16, v39
  v_and_b32 v33, 0xffff0000, v39
  v_cvt_pk_bf16_f32 v39, v34, v35
  v_lshlrev_b32 v34, 16, v39
  v_and_b32 v35, 0xffff0000, v39
  v_fma_f32 v41, -v38, v40, 1.0
  v_fma_f32 v40, v41, v40, v40
  v_mov_b32 v41, v40
  v_pk_mul_f32 v[28:29], v[28:29], v[40:41]
  v_pk_mul_f32 v[30:31], v[30:31], v[40:41]
  v_pk_mul_f32 v[32:33], v[32:33], v[40:41]
  v_pk_mul_f32 v[34:35], v[34:35], v[40:41]
  v_cvt_pk_bf16_f32 v24, v28, v29
  v_cvt_pk_bf16_f32 v25, v30, v31
  v_cvt_pk_bf16_f32 v26, v32, v33
  v_cvt_pk_bf16_f32 v27, v34, v35
  s_mov_b32 exec_hi, 0x00ffffff
  ds_write_b64 v44, v[24:25]
  ds_write_b64 v44, v[26:27] offset:16
  s_mov_b64 exec, -1
L_ffn_bc:
  s_waitcnt lgkmcnt(0)
  s_barrier
  s_cmp_eq_u32 s3, 7
  s_cbranch_scc1 L_ffn_w7
  ds_read_b128 v[40:43], v37
  ds_read_b128 v[44:47], v37 offset:64
  s_waitcnt lgkmcnt(0)
  v_mfma_f32_16x16x32_bf16 v[48:51], v[40:43], v[64:67], 0
  v_mfma_f32_16x16x32_bf16 v[52:55], v[40:43], v[68:71], 0
  v_mfma_f32_16x16x32_bf16 v[56:59], v[40:43], v[72:75], 0
  v_mfma_f32_16x16x32_bf16 v[60:63], v[40:43], v[76:79], 0
  v_mfma_f32_16x16x32_bf16 v[48:51], v[44:47], v[80:83], v[48:51]
  v_mfma_f32_16x16x32_bf16 v[52:55], v[44:47], v[84:87], v[52:55]
  v_mfma_f32_16x16x32_bf16 v[56:59], v[44:47], v[88:91], v[56:59]
  v_mfma_f32_16x16x32_bf16 v[60:63], v[44:47], v[92:95], v[60:63]
  s_nop 7
  v_cndmask_b32 v16, v48, v52, s[50:51]
  v_cndmask_b32 v16, v16, v56, s[52:53]
  v_cndmask_b32 v16, v16, v60, s[54:55]
  ds_write_b32 v116, v16
L_ffn_w7:
  s_waitcnt lgkmcnt(0)
  s_barrier
  s_cmp_eq_u32 s3, 7
  s_cbranch_scc1 L_exit
  ds_read_b32 v16, v117 offset:0
  ds_read_b32 v17, v117 offset:256
  ds_read_b32 v18, v117 offset:512
  ds_read_b32 v19, v117 offset:768
  ds_read_b32 v20, v117 offset:1024
  ds_read_b32 v21, v117 offset:1280
  ds_read_b32 v22, v117 offset:1536
  s_waitcnt lgkmcnt(5)
  v_add_f32 v16, v16, v17
  s_waitcnt lgkmcnt(4)
  v_add_f32 v16, v16, v18
  s_waitcnt lgkmcnt(3)
  v_add_f32 v16, v16, v19
  s_waitcnt lgkmcnt(2)
  v_add_f32 v16, v16, v20
  s_waitcnt lgkmcnt(1)
  v_add_f32 v16, v16, v21
  s_waitcnt lgkmcnt(0)
  v_add_f32 v16, v16, v22
  v_cvt_pk_bf16_f32 v17, v16, v16
  v_and_b32 v16, 0xffff0000, v17
  v_mov_b32 v17, v16
  s_nop 1
  v_permlane32_swap_b32 v16, v17
  s_nop 0
  v_mul_f32 v18, v16, v16
  v_fma_f32 v18, v18, s28, 1.0
  v_mul_f32 v18, v18, v16
  v_mul_f32 v18, s29, v18
  v_exp_f32 v18, v18
  s_nop 0
  v_add_f32 v18, 1.0, v18
  v_rcp_f32 v18, v18
  s_nop 0
  v_mul_f32 v18, v16, v18
  v_cvt_pk_bf16_f32 v18, v18, v18
  v_and_b32 v18, 0xffff0000, v18
  v_mul_f32 v18, v18, v17
  v_cvt_pk_bf16_f32 v18, v18, v18
  s_mov_b32 exec_hi, 0
  ds_write_b16 v118, v18
  s_mov_b32 exec_hi, -1
  ds_read_b128 v[20:23], v119
  s_waitcnt lgkmcnt(0)
  v_mfma_f32_16x16x32_bf16 v[48:51], v[20:23], v[96:99], 0
  v_mfma_f32_16x16x32_bf16 v[52:55], v[20:23], v[100:103], 0
  v_mfma_f32_16x16x32_bf16 v[56:59], v[20:23], v[104:107], 0
  v_mfma_f32_16x16x32_bf16 v[60:63], v[20:23], v[108:111], 0
  s_nop 7
  v_cndmask_b32 v16, v48, v52, s[50:51]
  v_cndmask_b32 v16, v16, v56, s[52:53]
  v_cndmask_b32 v16, v16, v60, s[54:55]
  s_nop 1
  v_mov_b32_dpp v20, v16 quad_perm:[0,0,0,0] row_mask:0xf bank_mask:0xf
  v_mov_b32_dpp v21, v16 quad_perm:[1,1,1,1] row_mask:0xf bank_mask:0xf
  v_mov_b32_dpp v22, v16 quad_perm:[2,2,2,2] row_mask:0xf bank_mask:0xf
  v_mov_b32_dpp v23, v16 quad_perm:[3,3,3,3] row_mask:0xf bank_mask:0xf
  s_mov_b32 exec_lo, 0x11111111
  s_mov_b32 exec_hi, 0x11111111
  global_store_dwordx4 v120, v[20:23], s[20:21] sc1
  s_mov_b64 exec, -1
  s_branch L_exit
L_fin:
  s_load_dwordx2 s[36:37], s[0:1], 72
  v_lshrrev_b32 v2, 4, v1
  v_and_b32 v3, 15, v1
  s_lshl_b32 s24, s3, 2
  v_add_u32 v4, s24, v2
  v_lshlrev_b32 v4, 11, v4
  v_lshl_add_u32 v4, v3, 4, v4
  s_lshl_b32 s25, s22, 8
  v_add_u32 v4, s25, v4
  v_add_u32 v5, 802816, v4
  v_add_u32 v6, 884736, v4
  v_add_u32 v7, 65536, v6
  v_bfrev_b32 v8, v2
  v_lshrrev_b32 v8, 30, v8
  v_lshl_add_u32 v8, v3, 2, v8
  v_lshlrev_b32 v8, 2, v8
  s_lshl_b32 s26, s3, 8
  s_add_u32 s26, s26, 122112
  v_add_u32 v8, s26, v8
  s_mov_b32 s30, 20000
L_fin1_5:
  global_load_dwordx4 v[12:15], v5, s[20:21] sc1
  s_waitcnt vmcnt(0)
  v_max3_u32 v10, v12, v13, v14
  v_max_u32 v10, v10, v15
  v_cmp_eq_u32 vcc, -1, v10
  s_cbranch_vccz L_fin1_done_6
  s_sub_u32 s30, s30, 1
  s_cmp_lg_u32 s30, 0
  s_cbranch_scc1 L_fin1_5
L_fin1_done_6:
  s_nop 1
  v_permlane32_swap_b32 v12, v13
  v_permlane32_swap_b32 v14, v15
  s_nop 0
  v_add_f32 v12, v12, v13
  v_add_f32 v14, v14, v15
  s_nop 1
  v_permlane16_swap_b32 v12, v14
  s_nop 0
  v_add_f32 v12, v12, v14
  ds_write_b32 v8, v12
  v_lshlrev_b32 v9, 2, v1
  v_add_u32 v9, 122112, v9
  s_lshl_b32 s25, s22, 7
  s_add_u32 s25, s25, 119808
  v_lshlrev_b32 v10, 1, v1
  v_add_u32 v11, s25, v10
  ds_read_u16 v32, v11
  s_lshl_b32 s27, s22, 8
  s_add_u32 s27, s27, 868352
  v_lshlrev_b32 v34, 2, v1
  v_add_u32 v34, s27, v34
  s_waitcnt lgkmcnt(0)
  s_barrier
  s_cmp_lg_u32 s3, 0
  s_cbranch_scc1 L_fin_fb
  ds_read_b32 v16, v9 offset:0
  ds_read_b32 v17, v9 offset:256
  ds_read_b32 v18, v9 offset:512
  ds_read_b32 v19, v9 offset:768
  ds_read_b32 v20, v9 offset:1024
  ds_read_b32 v21, v9 offset:1280
  ds_read_b32 v22, v9 offset:1536
  ds_read_b32 v23, v9 offset:1792
  v_lshlrev_b32 v32, 16, v32
  s_waitcnt lgkmcnt(6)
  v_add_f32 v16, v16, v17
  s_waitcnt lgkmcnt(5)
  v_add_f32 v16, v16, v18
  s_waitcnt lgkmcnt(4)
  v_add_f32 v16, v16, v19
  s_waitcnt lgkmcnt(3)
  v_add_f32 v16, v16, v20
  s_waitcnt lgkmcnt(2)
  v_add_f32 v16, v16, v21
  s_waitcnt lgkmcnt(1)
  v_add_f32 v16, v16, v22
  s_waitcnt lgkmcnt(0)
  v_add_f32 v16, v16, v23
  v_cvt_pk_bf16_f32 v33, v16, v16
  v_and_b32 v16, 0xffff0000, v33
  v_add_f32 v16, v16, v32
  v_cvt_pk_bf16_f32 v33, v16, v16
  v_and_b32 v40, 0xffff0000, v33
  s_nop 1
  v_mov_b32_dpp v36, v40 quad_perm:[0,0,0,0] row_mask:0xf bank_mask:0xf
  v_mov_b32_dpp v37, v40 quad_perm:[1,1,1,1] row_mask:0xf bank_mask:0xf
  v_mov_b32_dpp v38, v40 quad_perm:[2,2,2,2] row_mask:0xf bank_mask:0xf
  v_mov_b32_dpp v39, v40 quad_perm:[3,3,3,3] row_mask:0xf bank_mask:0xf
  s_mov_b32 exec_lo, 0x11111111
  s_mov_b32 exec_hi, 0x11111111
  global_store_dwordx4 v34, v[36:39], s[20:21] sc1
  s_mov_b64 exec, -1
L_fin_fb:
  s_cmp_lt_u32 s3, 6
  s_cbranch_scc1 L_fin_two
  s_mov_b32 s30, 20000
L_fin2a_7:
  global_load_dwordx4 v[12:15], v6, s[20:21] sc1
  s_waitcnt vmcnt(0)
  v_max3_u32 v10, v12, v13, v14
  v_max_u32 v10, v10, v15
  v_cmp_eq_u32 vcc, -1, v10
  s_cbranch_vccz L_fin2a_done_8
  s_sub_u32 s30, s30, 1
  s_cmp_lg_u32 s30, 0
  s_cbranch_scc1 L_fin2a_7
L_fin2a_done_8:
  s_branch L_fin_red
L_fin_two:
  s_mov_b32 s31, 3
  s_mov_b32 s30, 20000
L_fin2b_9:
  s_bitcmp1_b32 s31, 0
  s_cbranch_scc0 L_fin2b_9_nl0
  global_load_dwordx4 v[12:15], v6, s[20:21] sc1
L_fin2b_9_nl0:
  s_bitcmp1_b32 s31, 1
  s_cbranch_scc0 L_fin2b_9_nl1
  global_load_dwordx4 v[16:19], v7, s[20:21] sc1
L_fin2b_9_nl1:
  s_waitcnt vmcnt(0)
  v_max3_u32 v10, v12, v13, v14
  v_max_u32 v10, v10, v15
  v_cmp_eq_u32 vcc, -1, v10
  s_cbranch_vccnz L_fin2b_9_nc0
  s_bitset0_b32 s31, 0
L_fin2b_9_nc0:
  v_max3_u32 v10, v16, v17, v18
  v_max_u32 v10, v10, v19
  v_cmp_eq_u32 vcc, -1, v10
  s_cbranch_vccnz L_fin2b_9_nc1
  s_bitset0_b32 s31, 1
L_fin2b_9_nc1:
  s_cmp_eq_u32 s31, 0
  s_cbranch_scc1 L_fin2b_done_10
  s_sub_u32 s30, s30, 1
  s_cmp_lg_u32 s30, 0
  s_cbranch_scc1 L_fin2b_9
L_fin2b_done_10:
  v_add_f32 v12, v12, v16
  v_add_f32 v13, v13, v17
  v_add_f32 v14, v14, v18
  v_add_f32 v15, v15, v19
L_fin_red:
  s_nop 1
  v_permlane32_swap_b32 v12, v13
  v_permlane32_swap_b32 v14, v15
  s_nop 0
  v_add_f32 v12, v12, v13
  v_add_f32 v14, v14, v15
  s_nop 1
  v_permlane16_swap_b32 v12, v14
  s_nop 0
  v_add_f32 v12, v12, v14
  ds_write_b32 v8, v12 offset:2048
  s_waitcnt lgkmcnt(0)
  s_barrier
  s_cmp_lg_u32 s3, 0
  s_cbranch_scc1 L_exit
  ds_read_b32 v24, v9 offset:2048
  ds_read_b32 v25, v9 offset:2304
  ds_read_b32 v26, v9 offset:2560
  ds_read_b32 v27, v9 offset:2816
  ds_read_b32 v28, v9 offset:3072
  ds_read_b32 v29, v9 offset:3328
  ds_read_b32 v30, v9 offset:3584
  ds_read_b32 v31, v9 offset:3840
  s_waitcnt lgkmcnt(6)
  v_add_f32 v24, v24, v25
  s_waitcnt lgkmcnt(5)
  v_add_f32 v24, v24, v26
  s_waitcnt lgkmcnt(4)
  v_add_f32 v24, v24, v27
  s_waitcnt lgkmcnt(3)
  v_add_f32 v24, v24, v28
  s_waitcnt lgkmcnt(2)
  v_add_f32 v24, v24, v29
  s_waitcnt lgkmcnt(1)
  v_add_f32 v24, v24, v30
  s_waitcnt lgkmcnt(0)
  v_add_f32 v24, v24, v31
  v_cvt_pk_bf16_f32 v33, v24, v24
  v_and_b32 v24, 0xffff0000, v33
  v_add_f32 v16, v40, v24
  v_cvt_pk_bf16_f32 v33, v16, v16
  s_lshl_b32 s25, s22, 7
  v_lshlrev_b32 v10, 1, v1
  v_add_u32 v10, s25, v10
  global_store_short v10, v33, s[36:37]
  s_cmp_lg_u32 s22, 0
  s_cbranch_scc1 L_fin_end
  v_mov_b32 v34, 121852
  ds_read_b32 v35, v34
  s_waitcnt lgkmcnt(0)
  v_mov_b32 v34, 0
  s_mov_b64 exec, 1
  global_store_dword v34, v35, s[20:21] sc1
  s_mov_b64 exec, -1
L_fin_end:
  s_branch L_exit
L_helper:
  s_setprio 3
  s_load_dwordx2 s[56:57], s[0:1], 0
  s_load_dwordx2 s[8:9], s[0:1], 24
  s_and_b32 s24, s23, 7
  s_lshr_b32 s25, s23, 3
  s_mul_i32 s26, s25, 112
  s_lshl_b32 s27, s22, 3
  s_add_u32 s27, s27, s24
  s_lshl_b32 s27, s27, 7
  v_lshrrev_b32 v2, 3, v1
  v_add_u32 v3, s26, v2
  v_lshlrev_b32 v3, 13, v3
  v_and_b32 v4, 7, v1
  v_lshl_add_u32 v3, v4, 4, v3
  v_add_u32 v3, s27, v3
  v_lshlrev_b32 v5, 4, v1
  v_mov_b32 v6, 0
  s_waitcnt lgkmcnt(0)
  s_mov_b32 s40, s56
  s_mov_b32 s41, s57
  s_mov_b32 s42, 896
  s_mov_b32 s43, 0x20000
  s_mov_b32 s44, s8
  s_mov_b32 s45, s9
  s_mov_b32 s46, 3670016
  s_mov_b32 s47, 0x20000
  s_load_dword s36, s[20:21], 0x0
  buffer_load_dwordx4 v[8:11], v5, s[40:43], 0 offen
  s_mov_b32 s28, 0
  buffer_load_dwordx4 v[64:67], v3, s[44:47], s28 offen nt
  s_mov_b32 s28, 65536
  buffer_load_dwordx4 v[68:71], v3, s[44:47], s28 offen nt
  s_mov_b32 s28, 131072
  buffer_load_dwordx4 v[72:75], v3, s[44:47], s28 offen nt
  s_mov_b32 s28, 196608
  buffer_load_dwordx4 v[76:79], v3, s[44:47], s28 offen nt
  s_mov_b32 s28, 262144
  buffer_load_dwordx4 v[80:83], v3, s[44:47], s28 offen nt
  s_mov_b32 s28, 327680
  buffer_load_dwordx4 v[84:87], v3, s[44:47], s28 offen nt
  s_mov_b32 s28, 393216
  buffer_load_dwordx4 v[88:91], v3, s[44:47], s28 offen nt
  s_mov_b32 s28, 458752
  buffer_load_dwordx4 v[92:95], v3, s[44:47], s28 offen nt
  s_mov_b32 s28, 524288
  buffer_load_dwordx4 v[96:99], v3, s[44:47], s28 offen nt
  s_mov_b32 s28, 589824
  buffer_load_dwordx4 v[100:103], v3, s[44:47], s28 offen nt
  s_mov_b32 s28, 655360
  buffer_load_dwordx4 v[104:107], v3, s[44:47], s28 offen nt
  s_mov_b32 s28, 720896
  buffer_load_dwordx4 v[108:111], v3, s[44:47], s28 offen nt
  s_mov_b32 s28, 786432
  buffer_load_dwordx4 v[112:115], v3, s[44:47], s28 offen nt
  s_mov_b32 s28, 851968
  buffer_load_dwordx4 v[116:119], v3, s[44:47], s28 offen nt
  s_cmp_lg_u32 s23, 0
  s_cbranch_scc1 L_h_nocnt
  s_lshl_b32 s28, s22, 8
  s_add_u32 s28, s28, 229376
  v_mov_b32 v17, s28
  s_mov_b64 exec, 1
  global_store_dword v17, v6, s[20:21] sc1
  s_mov_b64 exec, -1
L_h_nocnt:
  v_mov_b32 v18, 122048
  ds_write_b32 v18, v6
  ds_write_b32 v18, v6 offset:4
  s_waitcnt lgkmcnt(0)
  s_barrier
  s_waitcnt vmcnt(14)
  v_add_u32 v18, 119808, v5
  v_cmp_gt_u32 vcc, 56, v1
  s_and_saveexec_b64 s[32:33], vcc
  ds_write_b128 v18, v[8:11]
  s_mov_b64 exec, s[32:33]
  v_lshlrev_b32 v20, 16, v8
  v_and_b32 v21, 0xffff0000, v8
  v_lshlrev_b32 v22, 16, v9
  v_and_b32 v23, 0xffff0000, v9
  v_lshlrev_b32 v24, 16, v10
  v_and_b32 v25, 0xffff0000, v10
  v_lshlrev_b32 v26, 16, v11
  v_and_b32 v27, 0xffff0000, v11
  s_mul_i32 s36, s36, 0x9E3779B1
  s_add_u32 s36, s36, 0x7F4A7C15
  v_mov_b32 v19, s36
  v_mov_b32 v18, 121852
  ds_write_b32 v18, v19
  v_readfirstlane_b32 s34, v20
  v_mov_b32 v36, 0
  v_mov_b32 v37, 0
  s_mov_b32 exec_hi, 0x00ffffff
  s_mov_b32 s35, s34
  v_pk_add_f32 v[28:29], v[20:21], s[34:35] neg_lo:[0,1] neg_hi:[0,1]
  v_pk_add_f32 v[30:31], v[22:23], s[34:35] neg_lo:[0,1] neg_hi:[0,1]
  v_pk_add_f32 v[32:33], v[24:25], s[34:35] neg_lo:[0,1] neg_hi:[0,1]
  v_pk_add_f32 v[34:35], v[26:27], s[34:35] neg_lo:[0,1] neg_hi:[0,1]
  v_pk_add_f32 v[40:41], v[28:29], v[30:31]
  v_pk_mul_f32 v[42:43], v[28:29], v[28:29]
  v_pk_add_f32 v[38:39], v[32:33], v[34:35]
  v_pk_fma_f32 v[42:43], v[30:31], v[30:31], v[42:43]
  v_pk_add_f32 v[40:41], v[40:41], v[38:39]
  v_pk_fma_f32 v[42:43], v[32:33], v[32:33], v[42:43]
  v_pk_fma_f32 v[42:43], v[34:35], v[34:35], v[42:43]
  v_add_f32 v36, v40, v41
  v_add_f32 v37, v42, v43
  s_mov_b64 exec, -1
  s_nop 1
  s_nop 0
  v_add_f32_dpp v36, v36, v36 row_ror:8 row_mask:0xf bank_mask:0xf
  v_add_f32_dpp v37, v37, v37 row_ror:8 row_mask:0xf bank_mask:0xf
  s_nop 0
  v_add_f32_dpp v36, v36, v36 row_ror:4 row_mask:0xf bank_mask:0xf
  v_add_f32_dpp v37, v37, v37 row_ror:4 row_mask:0xf bank_mask:0xf
  s_nop 0
  v_add_f32_dpp v36, v36, v36 row_ror:2 row_mask:0xf bank_mask:0xf
  v_add_f32_dpp v37, v37, v37 row_ror:2 row_mask:0xf bank_mask:0xf
  s_nop 0
  v_add_f32_dpp v36, v36, v36 row_ror:1 row_mask:0xf bank_mask:0xf
  v_add_f32_dpp v37, v37, v37 row_ror:1 row_mask:0xf bank_mask:0xf
  s_nop 0
  v_mov_b32 v38, v36
  v_mov_b32 v39, v37
  s_nop 1
  v_permlane16_swap_b32 v36, v38
  v_permlane16_swap_b32 v37, v39
  s_nop 0
  v_add_f32 v36, v36, v38
  v_add_f32 v37, v37, v39
  s_nop 0
  v_mov_b32 v38, v36
  v_mov_b32 v39, v37
  s_nop 1
  v_permlane32_swap_b32 v36, v38
  v_permlane32_swap_b32 v37, v39
  s_nop 0
  v_add_f32 v36, v36, v38
  v_add_f32 v37, v37, v39
  s_mov_b32 s35, 0x3b124925
  v_mul_f32 v36, s35, v36
  v_mul_f32 v37, s35, v37
  v_fma_f32 v37, -v36, v36, v37
  v_add_f32 v36, s34, v36
  v_max_f32 v37, 0, v37
  v_cvt_pk_bf16_f32 v38, v36, v37
  v_lshlrev_b32 v36, 16, v38
  v_and_b32 v37, 0xffff0000, v38
  v_add_f32 v37, 0x3727c5ac, v37
  v_cvt_pk_bf16_f32 v37, v37, v37
  v_and_b32 v37, 0xffff0000, v37
  v_sqrt_f32 v38, v37
  v_mov_b32 v37, v36
  v_pk_add_f32 v[28:29], v[20:21], v[36:37] neg_lo:[0,1] neg_hi:[0,1]
  v_pk_add_f32 v[30:31], v[22:23], v[36:37] neg_lo:[0,1] neg_hi:[0,1]
  v_pk_add_f32 v[32:33], v[24:25], v[36:37] neg_lo:[0,1] neg_hi:[0,1]
  v_pk_add_f32 v[34:35], v[26:27], v[36:37] neg_lo:[0,1] neg_hi:[0,1]
  v_cvt_pk_bf16_f32 v38, v38, v38
  v_and_b32 v38, 0xffff0000, v38
  v_rcp_f32 v40, v38
  v_cvt_pk_bf16_f32 v39, v28, v29
  v_lshlrev_b32 v28, 16, v39
  v_and_b32 v29, 0xffff0000, v39
  v_cvt_pk_bf16_f32 v39, v30, v31
  v_lshlrev_b32 v30, 16, v39
  v_and_b32 v31, 0xffff0000, v39
  v_cvt_pk_bf16_f32 v39, v32, v33
  v_lshlrev_b32 v32, 16, v39
  v_and_b32 v33, 0xffff0000, v39
  v_cvt_pk_bf16_f32 v39, v34, v35
  v_lshlrev_b32 v34, 16, v39
  v_and_b32 v35, 0xffff0000, v39
  v_fma_f32 v41, -v38, v40, 1.0
  v_fma_f32 v40, v41, v40, v40
  v_mov_b32 v41, v40
  v_pk_mul_f32 v[28:29], v[28:29], v[40:41]
  v_pk_mul_f32 v[30:31], v[30:31], v[40:41]
  v_pk_mul_f32 v[32:33], v[32:33], v[40:41]
  v_pk_mul_f32 v[34:35], v[34:35], v[40:41]
  v_cvt_pk_bf16_f32 v44, v28, v29
  v_cvt_pk_bf16_f32 v45, v30, v31
  v_cvt_pk_bf16_f32 v46, v32, v33
  v_cvt_pk_bf16_f32 v47, v34, v35
  v_add_u32 v18, 120832, v5
  v_cmp_gt_u32 vcc, 56, v1
  s_and_saveexec_b64 s[32:33], vcc
  ds_write_b128 v18, v[44:47]
  s_mov_b64 exec, s[32:33]
  v_add_u32 v18, s26, v2
  v_lshlrev_b32 v18, 1, v18
  v_add_u32 v18, 120832, v18
  s_waitcnt lgkmcnt(0)
  ds_read_u16 v48, v18 offset:0
  ds_read_u16 v49, v18 offset:16
  ds_read_u16 v50, v18 offset:32
  ds_read_u16 v51, v18 offset:48
  ds_read_u16 v52, v18 offset:64
  ds_read_u16 v53, v18 offset:80
  ds_read_u16 v54, v18 offset:96
  ds_read_u16 v55, v18 offset:112
  ds_read_u16 v56, v18 offset:128
  ds_read_u16 v57, v18 offset:144
  ds_read_u16 v58, v18 offset:160
  ds_read_u16 v59, v18 offset:176
  ds_read_u16 v60, v18 offset:192
  ds_read_u16 v61, v18 offset:208
  v_mov_b32 v28, 0
  v_mov_b32 v29, 0
  v_mov_b32 v30, 0
  v_mov_b32 v31, 0
  v_mov_b32 v32, 0
  v_mov_b32 v33, 0
  v_mov_b32 v34, 0
  v_mov_b32 v35, 0
  s_waitcnt vmcnt(0) lgkmcnt(0)
  v_lshlrev_b32 v62, 16, v48
  v_dot2c_f32_bf16 v28, v64, v48
  v_dot2c_f32_bf16 v29, v64, v62
  v_dot2c_f32_bf16 v30, v65, v48
  v_dot2c_f32_bf16 v31, v65, v62
  v_dot2c_f32_bf16 v32, v66, v48
  v_dot2c_f32_bf16 v33, v66, v62
  v_dot2c_f32_bf16 v34, v67, v48
  v_dot2c_f32_bf16 v35, v67, v62
  v_lshlrev_b32 v62, 16, v49
  v_dot2c_f32_bf16 v28, v68, v49
  v_dot2c_f32_bf16 v29, v68, v62
  v_dot2c_f32_bf16 v30, v69, v49
  v_dot2c_f32_bf16 v31, v69, v62
  v_dot2c_f32_bf16 v32, v70, v49
  v_dot2c_f32_bf16 v33, v70, v62
  v_dot2c_f32_bf16 v34, v71, v49
  v_dot2c_f32_bf16 v35, v71, v62
  v_lshlrev_b32 v62, 16, v50
  v_dot2c_f32_bf16 v28, v72, v50
  v_dot2c_f32_bf16 v29, v72, v62
  v_dot2c_f32_bf16 v30, v73, v50
  v_dot2c_f32_bf16 v31, v73, v62
  v_dot2c_f32_bf16 v32, v74, v50
  v_dot2c_f32_bf16 v33, v74, v62
  v_dot2c_f32_bf16 v34, v75, v50
  v_dot2c_f32_bf16 v35, v75, v62
  v_lshlrev_b32 v62, 16, v51
  v_dot2c_f32_bf16 v28, v76, v51
  v_dot2c_f32_bf16 v29, v76, v62
  v_dot2c_f32_bf16 v30, v77, v51
  v_dot2c_f32_bf16 v31, v77, v62
  v_dot2c_f32_bf16 v32, v78, v51
  v_dot2c_f32_bf16 v33, v78, v62
  v_dot2c_f32_bf16 v34, v79, v51
  v_dot2c_f32_bf16 v35, v79, v62
  v_lshlrev_b32 v62, 16, v52
  v_dot2c_f32_bf16 v28, v80, v52
  v_dot2c_f32_bf16 v29, v80, v62
  v_dot2c_f32_bf16 v30, v81, v52
  v_dot2c_f32_bf16 v31, v81, v62
  v_dot2c_f32_bf16 v32, v82, v52
  v_dot2c_f32_bf16 v33, v82, v62
  v_dot2c_f32_bf16 v34, v83, v52
  v_dot2c_f32_bf16 v35, v83, v62
  v_lshlrev_b32 v62, 16, v53
  v_dot2c_f32_bf16 v28, v84, v53
  v_dot2c_f32_bf16 v29, v84, v62
  v_dot2c_f32_bf16 v30, v85, v53
  v_dot2c_f32_bf16 v31, v85, v62
  v_dot2c_f32_bf16 v32, v86, v53
  v_dot2c_f32_bf16 v33, v86, v62
  v_dot2c_f32_bf16 v34, v87, v53
  v_dot2c_f32_bf16 v35, v87, v62
  v_lshlrev_b32 v62, 16, v54
  v_dot2c_f32_bf16 v28, v88, v54
  v_dot2c_f32_bf16 v29, v88, v62
  v_dot2c_f32_bf16 v30, v89, v54
  v_dot2c_f32_bf16 v31, v89, v62
  v_dot2c_f32_bf16 v32, v90, v54
  v_dot2c_f32_bf16 v33, v90, v62
  v_dot2c_f32_bf16 v34, v91, v54
  v_dot2c_f32_bf16 v35, v91, v62
  v_lshlrev_b32 v62, 16, v55
  v_dot2c_f32_bf16 v28, v92, v55
  v_dot2c_f32_bf16 v29, v92, v62
  v_dot2c_f32_bf16 v30, v93, v55
  v_dot2c_f32_bf16 v31, v93, v62
  v_dot2c_f32_bf16 v32, v94, v55
  v_dot2c_f32_bf16 v33, v94, v62
  v_dot2c_f32_bf16 v34, v95, v55
  v_dot2c_f32_bf16 v35, v95, v62
  v_lshlrev_b32 v62, 16, v56
  v_dot2c_f32_bf16 v28, v96, v56
  v_dot2c_f32_bf16 v29, v96, v62
  v_dot2c_f32_bf16 v30, v97, v56
  v_dot2c_f32_bf16 v31, v97, v62
  v_dot2c_f32_bf16 v32, v98, v56
  v_dot2c_f32_bf16 v33, v98, v62
  v_dot2c_f32_bf16 v34, v99, v56
  v_dot2c_f32_bf16 v35, v99, v62
  v_lshlrev_b32 v62, 16, v57
  v_dot2c_f32_bf16 v28, v100, v57
  v_dot2c_f32_bf16 v29, v100, v62
  v_dot2c_f32_bf16 v30, v101, v57
  v_dot2c_f32_bf16 v31, v101, v62
  v_dot2c_f32_bf16 v32, v102, v57
  v_dot2c_f32_bf16 v33, v102, v62
  v_dot2c_f32_bf16 v34, v103, v57
  v_dot2c_f32_bf16 v35, v103, v62
  v_lshlrev_b32 v62, 16, v58
  v_dot2c_f32_bf16 v28, v104, v58
  v_dot2c_f32_bf16 v29, v104, v62
  v_dot2c_f32_bf16 v30, v105, v58
  v_dot2c_f32_bf16 v31, v105, v62
  v_dot2c_f32_bf16 v32, v106, v58
  v_dot2c_f32_bf16 v33, v106, v62
  v_dot2c_f32_bf16 v34, v107, v58
  v_dot2c_f32_bf16 v35, v107, v62
  v_lshlrev_b32 v62, 16, v59
  v_dot2c_f32_bf16 v28, v108, v59
  v_dot2c_f32_bf16 v29, v108, v62
  v_dot2c_f32_bf16 v30, v109, v59
  v_dot2c_f32_bf16 v31, v109, v62
  v_dot2c_f32_bf16 v32, v110, v59
  v_dot2c_f32_bf16 v33, v110, v62
  v_dot2c_f32_bf16 v34, v111, v59
  v_dot2c_f32_bf16 v35, v111, v62
  v_lshlrev_b32 v62, 16, v60
  v_dot2c_f32_bf16 v28, v112, v60
  v_dot2c_f32_bf16 v29, v112, v62
  v_dot2c_f32_bf16 v30, v113, v60
  v_dot2c_f32_bf16 v31, v113, v62
  v_dot2c_f32_bf16 v32, v114, v60
  v_dot2c_f32_bf16 v33, v114, v62
  v_dot2c_f32_bf16 v34, v115, v60
  v_dot2c_f32_bf16 v35, v115, v62
  v_lshlrev_b32 v62, 16, v61
  v_dot2c_f32_bf16 v28, v116, v61
  v_dot2c_f32_bf16 v29, v116, v62
  v_dot2c_f32_bf16 v30, v117, v61
  v_dot2c_f32_bf16 v31, v117, v62
  v_dot2c_f32_bf16 v32, v118, v61
  v_dot2c_f32_bf16 v33, v118, v62
  v_dot2c_f32_bf16 v34, v119, v61
  v_dot2c_f32_bf16 v35, v119, v62
  s_nop 2
  v_permlane32_swap_b32 v28, v32
  v_permlane32_swap_b32 v29, v33
  v_permlane32_swap_b32 v30, v34
  v_permlane32_swap_b32 v31, v35
  s_nop 0
  v_add_f32 v28, v28, v32
  v_add_f32 v29, v29, v33
  v_add_f32 v30, v30, v34
  v_add_f32 v31, v31, v35
  s_nop 1
  v_permlane16_swap_b32 v28, v30
  v_permlane16_swap_b32 v29, v31
  s_nop 0
  v_add_f32 v28, v28, v30
  v_add_f32 v29, v29, v31
  s_nop 1
  v_add_f32_dpp v28, v28, v28 row_ror:8 row_mask:0xf bank_mask:0xf
  v_add_f32_dpp v29, v29, v29 row_ror:8 row_mask:0xf bank_mask:0xf
  v_mov_b32 v30, v29
  v_mov_b32 v29, s36
  v_mov_b32 v31, s36
  v_lshlrev_b32 v32, 6, v4
  v_bfe_u32 v33, v1, 5, 1
  v_lshl_add_u32 v32, v33, 5, v32
  v_bfe_u32 v33, v1, 4, 1
  v_lshl_add_u32 v32, v33, 4, v32
  s_lshl_b32 s28, s2, 9
  s_add_u32 s28, s28, 4096
  v_add_u32 v32, s28, v32
  v_and_b32 v33, 8, v1
  v_cmp_eq_u32 vcc, 0, v33
  s_and_saveexec_b64 s[32:33], vcc
  global_store_dwordx4 v32, v[28:31], s[20:21] sc1
  s_mov_b64 exec, s[32:33]
  s_getpc_b64 s[44:45]
L_pc:
  s_sub_u32 s44, s44, L_pc - sequential_preLN__gqa_block_cached__geglu_ffn__decode_kernel
  s_subb_u32 s45, s45, 0
  v_lshlrev_b32 v60, 7, v1
  v_cmp_gt_u32 vcc, L_end - sequential_preLN__gqa_block_cached__geglu_ffn__decode_kernel, v60
  s_and_saveexec_b64 s[46:47], vcc
  global_load_dword v61, v60, s[44:45]
  s_mov_b64 exec, s[46:47]
  v_add_u32 v60, 0x2000, v60
  v_cmp_gt_u32 vcc, L_end - sequential_preLN__gqa_block_cached__geglu_ffn__decode_kernel, v60
  s_and_saveexec_b64 s[46:47], vcc
  global_load_dword v62, v60, s[44:45]
  s_mov_b64 exec, s[46:47]
  v_add_u32 v60, 0x2000, v60
  v_mov_b32 v160, 122048
  v_mov_b32 v161, 1
  ds_write_b32 v160, v161 offset:4
  v_mov_b32 v153, s36
  s_branch L_sup_gather
L_h_resets:
  v_lshlrev_b32 v5, 4, v1
  v_mov_b32 v12, -1
  v_mov_b32 v13, -1
  v_mov_b32 v14, -1
  v_mov_b32 v15, -1
  s_lshl_b32 s28, s2, 11
  s_add_u32 s28, s28, 262144
  v_add_u32 v16, s28, v5
  s_lshl_b32 s28, s2, 4
  s_add_u32 s28, s28, 786432
  v_mov_b32 v17, s28
  s_mov_b64 exec, 1
  s_mov_b64 exec, -1
  s_mov_b32 s29, 0
  s_bitcmp1_b32 s23, 0
  s_cbranch_scc1 L_h_role_done
  s_cmp_lt_u32 s23, 8
  s_cbranch_scc0 L_h_not_t1
  s_mov_b32 s29, 1
  s_lshr_b32 s30, s23, 1
  s_lshl_b32 s31, s22, 2
  s_add_u32 s30, s30, s31
  s_lshl_b32 s31, s30, 11
  s_add_u32 s31, s31, 802816
  s_branch L_h_reset_role
L_h_not_t1:
  s_cmp_lt_u32 s23, 22
  s_cbranch_scc0 L_h_not_ffn
  s_mov_b32 s29, 2
  s_sub_u32 s30, s23, 8
  s_lshr_b32 s30, s30, 1
  s_lshl_b32 s30, s30, 3
  s_add_u32 s30, s30, s22
  s_lshl_b32 s31, s30, 11
  s_add_u32 s31, s31, 884736
L_h_reset_role:
  v_add_u32 v16, s31, v5
  s_branch L_h_role_done
L_h_not_ffn:
  s_cmp_eq_u32 s23, 22
  s_cbranch_scc0 L_h_role_done
  s_cmp_lt_u32 s22, 7
  s_cbranch_scc0 L_h_role_done
  s_mov_b32 s29, 3
  s_lshl_b32 s31, s22, 8
  s_add_u32 s31, s31, 868352
  v_add_u32 v16, s31, v5
  s_mov_b64 exec, 0xffff
  s_mov_b64 exec, -1
L_h_role_done:
  s_branch L_sup_dma
L_h_tokens:
  s_cmp_eq_u32 s29, 0
  s_cbranch_scc1 L_exit
  s_cmp_eq_u32 s29, 1
  s_cbranch_scc0 L_h_tok_fin
  v_and_b32 v20, 31, v1
  s_lshl_b32 s28, s22, 5
  v_add_u32 v20, s28, v20
  v_lshlrev_b32 v21, 2, v20
  v_add_u32 v21, 196608, v21
  s_mov_b32 s37, 20000
L_tok0_11:
  global_load_dword v23, v21, s[20:21] sc1
  s_waitcnt vmcnt(0)
  v_cmp_ne_u32 vcc, s36, v23
  s_cbranch_vccz L_tok0d_12
  s_sleep 8
  s_sub_u32 s37, s37, 1
  s_cmp_lg_u32 s37, 0
  s_cbranch_scc1 L_tok0_11
L_tok0d_12:
  s_branch L_h_end
L_h_tok_fin:
  s_cmp_eq_u32 s29, 3
  s_cbranch_scc1 L_h_tok_fin2
  v_min_u32 v20, 6, v1
  v_lshlrev_b32 v21, 5, v20
  v_add_u32 v21, 22, v21
  v_lshlrev_b32 v21, 2, v21
  v_add_u32 v21, 196608, v21
  s_mov_b32 s37, 20000
L_tokr_13:
  global_load_dword v23, v21, s[20:21] sc1
  s_waitcnt vmcnt(0)
  v_cmp_ne_u32 vcc, s36, v23
  s_cbranch_vccz L_tokrd_14
  s_sleep 8
  s_sub_u32 s37, s37, 1
  s_cmp_lg_u32 s37, 0
  s_cbranch_scc1 L_tokr_13
L_tokrd_14:
  s_branch L_h_end
L_h_tok_fin2:
  v_and_b32 v20, 31, v1
  v_lshrrev_b32 v21, 2, v20
  v_lshlrev_b32 v21, 5, v21
  v_and_b32 v22, 3, v20
  v_lshl_add_u32 v21, v22, 1, v21
  v_lshlrev_b32 v21, 2, v21
  v_add_u32 v21, 196608, v21
  s_mov_b32 s37, 20000
L_tok1_15:
  global_load_dword v23, v21, s[20:21] sc1
  s_waitcnt vmcnt(0)
  v_cmp_ne_u32 vcc, s36, v23
  s_cbranch_vccz L_tok1d_16
  s_sleep 8
  s_sub_u32 s37, s37, 1
  s_cmp_lg_u32 s37, 0
  s_cbranch_scc1 L_tok1_15
L_tok1d_16:
  v_min_u32 v20, 55, v1
  v_and_b32 v21, 7, v20
  v_lshlrev_b32 v21, 5, v21
  v_lshrrev_b32 v22, 3, v20
  v_lshl_add_u32 v21, v22, 1, v21
  v_add_u32 v21, 8, v21
  v_lshlrev_b32 v21, 2, v21
  v_add_u32 v21, 196608, v21
  s_mov_b32 s37, 20000
L_tok2_17:
  global_load_dword v23, v21, s[20:21] sc1
  s_waitcnt vmcnt(0)
  v_cmp_ne_u32 vcc, s36, v23
  s_cbranch_vccz L_tok2d_18
  s_sleep 8
  s_sub_u32 s37, s37, 1
  s_cmp_lg_u32 s37, 0
  s_cbranch_scc1 L_tok2_17
L_tok2d_18:
L_h_end:
  s_branch L_exit
L_support:
  s_setprio 3
  s_waitcnt lgkmcnt(0)
  s_load_dword s36, s[20:21], 0x0
  s_barrier
  s_cmp_eq_u32 s3, 9
  s_cbranch_scc0 L_sup_nores
  v_lshlrev_b32 v5, 4, v1
  v_mov_b32 v12, -1
  v_mov_b32 v13, -1
  v_mov_b32 v14, -1
  v_mov_b32 v15, -1
  s_lshl_b32 s28, s2, 11
  s_add_u32 s28, s28, 262144
  v_add_u32 v16, s28, v5
  global_store_dwordx4 v16, v[12:15], s[20:21] sc1
  global_store_dwordx4 v16, v[12:15], s[20:21] offset:1024 sc1
  s_lshl_b32 s28, s2, 4
  s_add_u32 s28, s28, 786432
  v_mov_b32 v17, s28
  s_mov_b64 exec, 1
  global_store_dwordx4 v17, v[12:15], s[20:21] sc1
  s_mov_b64 exec, -1
  s_mov_b32 s29, 0
  s_bitcmp1_b32 s23, 0
  s_cbranch_scc1 L_e_role_done
  s_cmp_lt_u32 s23, 8
  s_cbranch_scc0 L_e_not_t1
  s_mov_b32 s29, 1
  s_lshr_b32 s30, s23, 1
  s_lshl_b32 s31, s22, 2
  s_add_u32 s30, s30, s31
  s_lshl_b32 s31, s30, 11
  s_add_u32 s31, s31, 802816
  s_branch L_e_reset_role
L_e_not_t1:
  s_cmp_lt_u32 s23, 22
  s_cbranch_scc0 L_e_not_ffn
  s_mov_b32 s29, 2
  s_sub_u32 s30, s23, 8
  s_lshr_b32 s30, s30, 1
  s_lshl_b32 s30, s30, 3
  s_add_u32 s30, s30, s22
  s_lshl_b32 s31, s30, 11
  s_add_u32 s31, s31, 884736
L_e_reset_role:
  v_add_u32 v16, s31, v5
  global_store_dwordx4 v16, v[12:15], s[20:21] sc1
  global_store_dwordx4 v16, v[12:15], s[20:21] offset:1024 sc1
  s_branch L_e_role_done
L_e_not_ffn:
  s_cmp_eq_u32 s23, 22
  s_cbranch_scc0 L_e_role_done
  s_cmp_lt_u32 s22, 7
  s_cbranch_scc0 L_e_role_done
  s_mov_b32 s29, 3
  s_lshl_b32 s31, s22, 8
  s_add_u32 s31, s31, 868352
  v_add_u32 v16, s31, v5
  s_mov_b64 exec, 0xffff
  global_store_dwordx4 v16, v[12:15], s[20:21] sc1
  s_mov_b64 exec, -1
L_e_role_done:
L_sup_nores:
  s_waitcnt lgkmcnt(0)
  s_mul_i32 s36, s36, 0x9E3779B1
  s_add_u32 s36, s36, 0x7F4A7C15
  v_mov_b32 v153, s36
  s_cmp_eq_u32 s3, 9
  s_cbranch_scc0 L_sup_notok
  s_waitcnt vmcnt(0)
  s_lshl_b32 s28, s2, 2
  s_add_u32 s28, s28, 196608
  v_mov_b32 v17, s28
  v_mov_b32 v18, s36
  s_mov_b64 exec, 1
  global_store_dword v17, v18, s[20:21] sc1
  s_mov_b64 exec, -1
L_sup_notok:
  v_mov_b32 v160, 122048
  s_mov_b32 s37, 320000
L_sup_wait:
  ds_read_b32 v161, v160 offset:4
  s_waitcnt lgkmcnt(0)
  v_readfirstlane_b32 s42, v161
  s_cmp_lg_u32 s42, 0
  s_cbranch_scc1 L_sup_gather
  s_sleep 2
  s_sub_u32 s37, s37, 1
  s_cmp_lg_u32 s37, 0
  s_cbranch_scc1 L_sup_wait
L_sup_gather:
  s_load_dwordx2 s[60:61], s[0:1], 32
  s_load_dwordx4 s[64:67], s[0:1], 48
  s_load_dwordx2 s[62:63], s[0:1], 64
  s_sub_u32 s28, s3, 8
  s_lshl_b32 s27, s22, 5
  s_add_u32 s27, s27, s28
  s_lshl_b32 s27, s27, 9
  s_add_u32 s27, s27, 4096
  v_lshrrev_b32 v150, 5, v1
  v_lshlrev_b32 v150, 12, v150
  v_and_b32 v152, 31, v1
  v_lshl_add_u32 v150, v152, 4, v150
  v_add_u32 v150, s27, v150
  v_add_u32 v151, 0x2000, v150
  s_lshl_b32 s27, s28, 7
  s_add_u32 s27, s27, 118784
  v_lshlrev_b32 v152, 2, v152
  v_add_u32 v152, s27, v152
  s_mov_b32 s37, 20000
  s_mov_b32 s42, 15
L_qpoll:
  s_bitcmp1_b32 s42, 0
  s_cbranch_scc0 L_qnl0
  global_load_dwordx4 v[40:43], v150, s[20:21] offset:0 sc1
L_qnl0:
  s_bitcmp1_b32 s42, 1
  s_cbranch_scc0 L_qnl1
  global_load_dwordx4 v[44:47], v151, s[20:21] offset:0 sc1
L_qnl1:
  s_bitcmp1_b32 s42, 2
  s_cbranch_scc0 L_qnl2
  global_load_dwordx4 v[48:51], v150, s[20:21] offset:2048 sc1
L_qnl2:
  s_bitcmp1_b32 s42, 3
  s_cbranch_scc0 L_qnl3
  global_load_dwordx4 v[52:55], v151, s[20:21] offset:2048 sc1
L_qnl3:
  s_waitcnt vmcnt(0)
  v_xor_b32 v154, v41, v153
  v_bitop3_b32 v154, v154, v43, v153 bitop3:0xf6
  v_cmp_ne_u32 vcc, 0, v154
  s_cbranch_vccnz L_qnc0
  s_bitset0_b32 s42, 0
L_qnc0:
  v_xor_b32 v154, v45, v153
  v_bitop3_b32 v154, v154, v47, v153 bitop3:0xf6
  v_cmp_ne_u32 vcc, 0, v154
  s_cbranch_vccnz L_qnc1
  s_bitset0_b32 s42, 1
L_qnc1:
  v_xor_b32 v154, v49, v153
  v_bitop3_b32 v154, v154, v51, v153 bitop3:0xf6
  v_cmp_ne_u32 vcc, 0, v154
  s_cbranch_vccnz L_qnc2
  s_bitset0_b32 s42, 2
L_qnc2:
  v_xor_b32 v154, v53, v153
  v_bitop3_b32 v154, v154, v55, v153 bitop3:0xf6
  v_cmp_ne_u32 vcc, 0, v154
  s_cbranch_vccnz L_qnc3
  s_bitset0_b32 s42, 3
L_qnc3:
  s_cmp_eq_u32 s42, 0
  s_cbranch_scc1 L_qdone
  s_sub_u32 s37, s37, 1
  s_cmp_lg_u32 s37, 0
  s_cbranch_scc1 L_qpoll
L_qdone:
  v_add_f32 v40, v40, v44
  v_add_f32 v42, v42, v46
  v_mov_b32 v44, v40
  v_mov_b32 v46, v42
  v_add_f32 v48, v48, v52
  v_add_f32 v50, v50, v54
  v_mov_b32 v52, v48
  v_mov_b32 v54, v50
  s_nop 1
  v_permlane32_swap_b32 v40, v44
  v_permlane32_swap_b32 v42, v46
  v_permlane32_swap_b32 v48, v52
  v_permlane32_swap_b32 v50, v54
  s_nop 0
  v_add_f32 v40, v40, v44
  v_add_f32 v42, v42, v46
  v_cvt_pk_bf16_f32 v40, v40, v42
  ds_write_b32 v152, v40 offset:0
  v_add_f32 v48, v48, v52
  v_add_f32 v50, v50, v54
  v_cvt_pk_bf16_f32 v48, v48, v50
  ds_write_b32 v152, v48 offset:512
  s_waitcnt lgkmcnt(0)
  v_mov_b32 v160, 122048
  v_mov_b32 v161, 1
  s_mov_b64 exec, 1
  ds_add_u32 v160, v161
  s_mov_b64 exec, -1
  s_barrier
  s_cmp_eq_u32 s3, 8
  s_cbranch_scc1 L_h_resets
L_sup_dma:
  s_bitcmp1_b32 s23, 0
  s_cbranch_scc1 L_wd_done
  s_cmp_lt_u32 s23, 22
  s_cbranch_scc0 L_wd_done
  s_sub_u32 s34, s3, 8
  v_lshlrev_b32 v144, 4, v1
  s_cmp_lt_u32 s23, 8
  s_cbranch_scc0 L_wd_ffn
  s_mov_b32 s88, s60
  s_mov_b32 s89, s61
  s_mov_b32 s90, 3670016
  s_mov_b32 s91, 0x20000
  s_lshr_b32 s30, s23, 1
  s_lshl_b32 s31, s22, 2
  s_add_u32 s30, s30, s31
  s_lshl_b32 s30, s30, 7
  s_mul_i32 s31, s34, 32
  s_add_u32 s30, s30, s31
  s_mul_i32 s38, s30, 896
  s_mul_i32 s39, s31, 928
  s_mov_b32 s49, 32
  s_mov_b32 exec_hi, 0x00ffffff
L_rows_19:
  s_mov_b32 m0, s39
  s_add_u32 s39, s39, 928
  buffer_load_dwordx4 v144, s[88:91], s38 offen nt lds
  s_add_u32 s38, s38, 896
  s_waitcnt vmcnt(48)
  s_sub_u32 s49, s49, 1
  s_cmp_lg_u32 s49, 0
  s_cbranch_scc1 L_rows_19
  s_mov_b64 exec, -1
  s_branch L_wd_done
L_wd_ffn:
  s_sub_u32 s30, s23, 8
  s_lshr_b32 s30, s30, 1
  s_lshl_b32 s30, s30, 3
  s_add_u32 s30, s30, s22
  v_lshrrev_b32 v145, 2, v1
  v_bfe_u32 v146, v1, 4, 1
  v_lshlrev_b32 v146, 1, v146
  v_and_b32 v147, 3, v1
  v_xor_b32 v147, v147, v146
  v_mul_u32_u24 v145, 3584, v145
  v_lshl_add_u32 v145, v147, 4, v145
  s_mov_b32 s88, s64
  s_mov_b32 s89, s65
  s_mov_b32 s90, 1605632
  s_mov_b32 s91, 0x20000
  s_mul_i32 s38, s34, 57344
  s_lshl_b32 s31, s30, 6
  s_add_u32 s38, s38, s31
  s_lshl_b32 s39, s34, 10
  s_add_u32 s39, s39, 0
  s_mov_b32 s49, s34
L_gu_20:
  s_mov_b32 m0, s39
  s_add_u32 s39, s39, 4096
  buffer_load_dwordx4 v145, s[88:91], s38 offen nt lds
  s_add_u32 s38, s38, 229376
  s_add_u32 s49, s49, 4
  s_cmp_lt_u32 s49, 28
  s_cbranch_scc1 L_gu_20
  s_mov_b32 s88, s66
  s_mov_b32 s89, s67
  s_mov_b32 s90, 1605632
  s_mov_b32 s91, 0x20000
  s_mul_i32 s38, s34, 57344
  s_lshl_b32 s31, s30, 6
  s_add_u32 s38, s38, s31
  s_lshl_b32 s39, s34, 10
  s_add_u32 s39, s39, 28672
  s_mov_b32 s49, s34
L_gu_21:
  s_mov_b32 m0, s39
  s_add_u32 s39, s39, 4096
  buffer_load_dwordx4 v145, s[88:91], s38 offen nt lds
  s_add_u32 s38, s38, 229376
  s_add_u32 s49, s49, 4
  s_cmp_lt_u32 s49, 28
  s_cbranch_scc1 L_gu_21
  s_mov_b32 s88, s62
  s_mov_b32 s89, s63
  s_mov_b32 s90, 1605632
  s_mov_b32 s91, 0x20000
  s_lshl_b32 s31, s30, 5
  s_mul_i32 s49, s34, 8
  s_add_u32 s31, s31, s49
  s_mul_i32 s38, s31, 896
  s_mul_i32 s39, s49, 928
  s_add_u32 s39, s39, 57344
  s_mov_b32 s49, 8
  s_mov_b32 exec_hi, 0x00ffffff
L_rows_22:
  s_mov_b32 m0, s39
  s_add_u32 s39, s39, 928
  buffer_load_dwordx4 v144, s[88:91], s38 offen nt lds
  s_add_u32 s38, s38, 896
  s_waitcnt vmcnt(48)
  s_sub_u32 s49, s49, 1
  s_cmp_lg_u32 s49, 0
  s_cbranch_scc1 L_rows_22
  s_mov_b64 exec, -1
L_wd_done:
  s_waitcnt vmcnt(0)
  s_cmp_eq_u32 s3, 8
  s_cbranch_scc1 L_h_tokens
  s_branch L_exit
L_exit:
L_end:
  s_endpgm
.section .rodata,"a"
.p2align 6
.amdhsa_kernel sequential_preLN__gqa_block_cached__geglu_ffn__decode_kernel
  .amdhsa_next_free_vgpr 168
  .amdhsa_next_free_sgpr 102
  .amdhsa_accum_offset 168
  .amdhsa_group_segment_fixed_size 0
  .amdhsa_kernarg_size 96
  .amdhsa_user_sgpr_count 2
  .amdhsa_user_sgpr_kernarg_segment_ptr 1
  .amdhsa_system_sgpr_workgroup_id_x 1
  .amdhsa_float_denorm_mode_32 3
  .amdhsa_float_denorm_mode_16_64 3
.end_amdhsa_kernel
```
